```python
import torch

def _softmax(x, axis=-1):
    return torch.softmax(x, dim=axis)
def _gelu(x):
    return torch.nn.functional.gelu(x, approximate="tanh")
def _silu(x):
    return torch.nn.functional.silu(x)
def _sigmoid(x):
    return torch.sigmoid(x)
def _layernorm(x, axis=-1, eps=1e-5):
    m = x.mean(dim=axis, keepdim=True)
    v = x.var(dim=axis, keepdim=True, unbiased=False)
    return (x - m) / torch.sqrt(v + eps)
def _scatter_add(tgt, idx, src, axis=0):
    return tgt.clone().index_add_(axis, idx, src)
def _segment_sum(src, seg, n):
    out = torch.zeros((n,) + src.shape[1:], dtype=src.dtype)
    return out.index_add_(0, seg, src)
def _pad(x, pw):
    flat = tuple(v for pair in reversed(pw) for v in pair)
    return torch.nn.functional.pad(x, flat)

kernel_name = 'interleave_layers__ssm_conv_h3__swiglu_ffn__prompt'

def setup_inputs():

    _w = (lambda a: (lambda t: t.to(torch.bfloat16) if t.is_floating_point() else t)(torch.as_tensor(a)))
    def _A_setup():
        B, S, D = 1, 2048, 448
        ks = 4
        return {
            "q": _w((lambda *s: torch.randn(*s, dtype=torch.bfloat16) * 0.05)(B, S, D)),
            "k": _w((lambda *s: torch.randn(*s, dtype=torch.bfloat16) * 0.8)(B, S, D)),
            "v": _w((lambda *s: torch.randn(*s, dtype=torch.bfloat16) * 0.8)(B, S, D)),
            "shift_k": _w((lambda *s: torch.randn(*s, dtype=torch.bfloat16) * 0.8)(D, ks) * 0.5),
            "ssm_k": _w((lambda *s: torch.randn(*s, dtype=torch.bfloat16) * 0.8)(D, S) * (1.0 / S ** 0.5)),
            "ssm_D": _w((lambda *s: torch.randn(*s, dtype=torch.bfloat16) * 0.8)(D)),
        }
    _A_in = _A_setup()

    def _B_setup():
        B, S, D, F = 1, 2048, 448, 1792
        return {
            "x": _w((lambda *s: torch.randn(*s, dtype=torch.bfloat16) * 0.05)(B, S, D)),
            "w_gate": _w((lambda *s: torch.randn(*s, dtype=torch.bfloat16) * 0.1)(D, F)),
            "w_up": _w((lambda *s: torch.randn(*s, dtype=torch.bfloat16) * 0.1)(D, F)),
            "w_down": _w((lambda *s: torch.randn(*s, dtype=torch.bfloat16) * 0.1)(F, D)),
        }
    _B_in = _B_setup()

    return {
        "A_q": _A_in["q"],
        "A_k": _A_in["k"],
        "A_v": _A_in["v"],
        "A_shift_k": _A_in["shift_k"],
        "A_ssm_k": _A_in["ssm_k"],
        "A_ssm_D": _A_in["ssm_D"],
        "B_x": _B_in["x"],
        "B_w_gate": _B_in["w_gate"],
        "B_w_up": _B_in["w_up"],
        "B_w_down": _B_in["w_down"],
    }

def reference(A_q, A_k, A_v, A_shift_k, A_ssm_k, A_ssm_D, B_x, B_w_gate, B_w_up, B_w_down):
    def _A_ref(q, k, v, shift_k, ssm_k, ssm_D):
        B, S, D = q.shape
        ks = shift_k.shape[-1]
        k_pad = _pad(k, ((0, 0), (ks - 1, 0), (0, 0)))
        k_shift = torch.zeros_like(k)
        for t in range(ks):
            k_shift = k_shift + k_pad[:, t:t + S, :] * shift_k[:, ks - 1 - t][None, None, :]
        kv = k_shift * v
        L = 2 * S
        kv_pad = _pad(kv, ((0, 0), (0, S), (0, 0)))
        kf_pad = _pad(ssm_k, ((0, 0), (0, S)))
        kv_f = (lambda x, axes=(-2,-1): torch.fft.rfft2(x.float(), dim=axes))(kv_pad[:, None, :, :], axes=(1, 2))
        kf_f = (lambda x, axes=(-2,-1): torch.fft.rfft2(x.float(), dim=axes))(kf_pad[:, None, :], axes=(1, 2))
        kf_f = (lambda x, *d: x.permute(*d))(kf_f, 1, 2, 0)
        y_f = kv_f * kf_f[None, :, :, :]
        y = (lambda x, s, axes=(-2,-1): torch.fft.irfft2(x, s=s, dim=axes).to(torch.bfloat16))(y_f, (1, L), axes=(1, 2))[:, 0, :S, :]
        y = y + kv * ssm_D[None, None, :]
        return q * y

    def _B_ref(x, w_gate, w_up, w_down):
        g = _silu(x @ w_gate)
        u = x @ w_up
        return (g * u) @ w_down

    x = A_q
    x = x + _A_ref(_layernorm(x, axis=-1), A_k, A_v, A_shift_k, A_ssm_k, A_ssm_D)
    x = x + _B_ref(_layernorm(x, axis=-1), B_w_gate, B_w_up, B_w_down)
    x = x + _A_ref(_layernorm(x, axis=-1), A_k, A_v, A_shift_k, A_ssm_k, A_ssm_D)
    x = x + _B_ref(_layernorm(x, axis=-1), B_w_gate, B_w_up, B_w_down)
    return x
```

```asm
; @launch grid=(256,1,1) block=(256,1,1) lds=163840
.amdgcn_target "amdgcn-amd-amdhsa--gfx950"
.text
.globl interleave_layers__ssm_conv_h3__swiglu_ffn__prompt_kernel
.p2align 8
.type interleave_layers__ssm_conv_h3__swiglu_ffn__prompt_kernel,@function
interleave_layers__ssm_conv_h3__swiglu_ffn__prompt_kernel:
  s_cmp_ge_u32 s2, 256
  s_cbranch_scc1 L_end
  s_load_dwordx16 s[64:79], s[0:1], 0
  s_load_dwordx8 s[80:87], s[0:1], 64
  s_load_dwordx2 s[88:89], s[0:1], 96
  v_lshrrev_b32 v1, 6, v0
  v_and_b32 v2, 63, v0
  v_readfirstlane_b32 s3, v1
  v_lshlrev_b32 v3, 4, v2
  s_and_b32 s90, s2, 7
  s_lshr_b32 s63, s2, 4
  s_waitcnt lgkmcnt(0)
  s_add_u32 s92, s88, 0x2600000
  s_addc_u32 s93, s89, 0
  s_mov_b32 s94, 0x10000
  s_mov_b32 s95, 0x20000
  s_add_u32 s4, s88, 0x1000000
  s_addc_u32 s5, s89, 0
  s_mov_b32 s6, 0x310000
  s_mov_b32 s7, 0x20000
  s_add_u32 s8, s88, 0x1400000
  s_addc_u32 s9, s89, 0
  s_mov_b32 s10, 0x188000
  s_mov_b32 s11, 0x20000
  s_cmp_lg_u32 s2, 255
  s_cbranch_scc1 L_ini_1
  v_mov_b32 v8, 0
  v_mov_b32 v9, 0
  v_mov_b32 v10, 0
  v_mov_b32 v11, 0
  s_mul_i32 s12, s3, 15360
  buffer_store_dwordx4 v[8:11], v3, s[92:95], s12 offen sc1
  s_add_u32 s12, s12, 1024
  buffer_store_dwordx4 v[8:11], v3, s[92:95], s12 offen sc1
  s_add_u32 s12, s12, 1024
  buffer_store_dwordx4 v[8:11], v3, s[92:95], s12 offen sc1
  s_add_u32 s12, s12, 1024
  buffer_store_dwordx4 v[8:11], v3, s[92:95], s12 offen sc1
  s_add_u32 s12, s12, 1024
  buffer_store_dwordx4 v[8:11], v3, s[92:95], s12 offen sc1
  s_add_u32 s12, s12, 1024
  buffer_store_dwordx4 v[8:11], v3, s[92:95], s12 offen sc1
  s_add_u32 s12, s12, 1024
  buffer_store_dwordx4 v[8:11], v3, s[92:95], s12 offen sc1
  s_add_u32 s12, s12, 1024
  buffer_store_dwordx4 v[8:11], v3, s[92:95], s12 offen sc1
  s_add_u32 s12, s12, 1024
  buffer_store_dwordx4 v[8:11], v3, s[92:95], s12 offen sc1
  s_add_u32 s12, s12, 1024
  buffer_store_dwordx4 v[8:11], v3, s[92:95], s12 offen sc1
  s_add_u32 s12, s12, 1024
  buffer_store_dwordx4 v[8:11], v3, s[92:95], s12 offen sc1
  s_add_u32 s12, s12, 1024
  buffer_store_dwordx4 v[8:11], v3, s[92:95], s12 offen sc1
  s_add_u32 s12, s12, 1024
  buffer_store_dwordx4 v[8:11], v3, s[92:95], s12 offen sc1
  s_add_u32 s12, s12, 1024
  buffer_store_dwordx4 v[8:11], v3, s[92:95], s12 offen sc1
  s_add_u32 s12, s12, 1024
  buffer_store_dwordx4 v[8:11], v3, s[92:95], s12 offen sc1
  s_add_u32 s12, s12, 1024
  s_mov_b32 s56, s86
  s_mov_b32 s57, s87
  s_mov_b32 s58, 0x100
  s_mov_b32 s59, 0x20000
  s_waitcnt vmcnt(0)
  s_barrier
  s_cmp_lg_u32 s3, 3
  s_cbranch_scc1 L_ini_1
  v_mov_b32 v4, 0
  v_mov_b32 v5, 1
  s_mov_b64 exec, 1
  buffer_store_dword v5, v4, s[56:59], 0 offen sc1
  s_mov_b64 exec, -1
L_ini_1:
  s_lshl_b32 s48, s2, 2
  s_add_u32 s48, s48, s3
  v_and_b32 v33, 7, v2
  v_lshrrev_b32 v4, 3, v2
  s_mul_i32 s12, s3, 14
  v_add_u32 v5, s12, v4
  s_lshr_b32 s13, s2, 2
  s_mul_i32 s13, s13, 28672
  s_and_b32 s14, s2, 3
  s_lshl_b32 s14, s14, 7
  s_add_u32 s13, s13, s14
  v_lshlrev_b32 v6, 9, v5
  v_lshl_add_u32 v6, v33, 4, v6
  v_add_u32 v6, s13, v6
  v_add_u32 v7, 4096, v6
  v_mov_b32 v8, 0x80000000
  v_cmp_gt_u32 vcc, 6, v4
  v_cmp_gt_u32 s[38:39], 6, v4
  s_nop 0
  v_cndmask_b32 v7, v8, v7, vcc
  v_lshlrev_b32 v15, 3, v33
  v_add_u32 v15, 8064, v15
  s_lshl_b32 s37, s3, 6
  v_add_u32 v32, s37, v15
  s_mov_b32 s28, s64
  s_mov_b32 s29, s65
  s_mov_b32 s30, 0x1c0000
  s_mov_b32 s31, 0x20000
  s_mul_i32 s15, s2, 8*896
  v_mul_u32_u24 v9, 896, v33
  v_lshl_add_u32 v9, v5, 4, v9
  v_add_u32 v9, s15, v9
  v_add_u32 v10, 128, v9
  v_cndmask_b32 v10, v8, v10, s[38:39]
  s_cmp_ge_u32 s2, 224
  s_cbranch_scc1 L_nokv_2
  s_mul_hi_u32 s12, s2, 0x24924925
  s_mul_i32 s13, s12, 7
  s_sub_u32 s13, s2, s13
  s_mov_b32 s62, s13
  v_and_b32 v40, 7, v2
  v_lshrrev_b32 v1, 3, v2
  s_lshl_b32 s14, s3, 5
  s_lshl_b32 s15, s13, 7
  s_add_u32 s14, s14, s15
  v_lshl_add_u32 v41, v1, 2, s14
  s_mul_i32 s15, s12, 64*896
  v_mul_u32_u24 v42, 8*896, v40
  v_add3_u32 v42, v42, v41, s15
  v_add_u32 v43, 5*896, v42
  v_subrev_u32 v44, 3*896, v42
  v_lshlrev_b32 v45, 2, v41
  s_mov_b32 s16, s66
  s_mov_b32 s17, s67
  s_mov_b32 s18, 0x1c0000
  s_mov_b32 s19, 0x20000
  s_mov_b32 s20, s68
  s_mov_b32 s21, s69
  s_mov_b32 s22, 0x1c0000
  s_mov_b32 s23, 0x20000
  s_mov_b32 s24, s70
  s_mov_b32 s25, s71
  s_mov_b32 s26, 0xe00
  s_mov_b32 s27, 0x20000
  buffer_load_dword v16, v44, s[16:19], 0 offen offset:0
  buffer_load_dword v17, v44, s[16:19], 0 offen offset:896
  buffer_load_dword v18, v44, s[16:19], 0 offen offset:1792
  buffer_load_dword v19, v42, s[16:19], 0 offen offset:0
  buffer_load_dword v20, v42, s[16:19], 0 offen offset:896
  buffer_load_dword v21, v42, s[16:19], 0 offen offset:1792
  buffer_load_dword v22, v42, s[16:19], 0 offen offset:2688
  buffer_load_dword v23, v42, s[16:19], 0 offen offset:3584
  buffer_load_dword v24, v43, s[16:19], 0 offen offset:0
  buffer_load_dword v25, v43, s[16:19], 0 offen offset:896
  buffer_load_dword v26, v43, s[16:19], 0 offen offset:1792
  buffer_load_dword v48, v42, s[20:23], 0 offen offset:0
  buffer_load_dword v49, v42, s[20:23], 0 offen offset:896
  buffer_load_dword v50, v42, s[20:23], 0 offen offset:1792
  buffer_load_dword v51, v42, s[20:23], 0 offen offset:2688
  buffer_load_dword v52, v42, s[20:23], 0 offen offset:3584
  buffer_load_dword v53, v43, s[20:23], 0 offen offset:0
  buffer_load_dword v54, v43, s[20:23], 0 offen offset:896
  buffer_load_dword v55, v43, s[20:23], 0 offen offset:1792
  buffer_load_dwordx4 v[36:39], v45, s[24:27], 0 offen
  s_lshl_b32 s13, s13, 6
  s_lshl_b32 s14, s12, 1
  s_add_u32 s13, s13, s14
  s_lshr_b32 s14, s3, 1
  s_and_b32 s51, s3, 1
  s_add_u32 s50, s13, s14
  s_mul_i32 s52, s14, 37888
  s_lshl_b32 s16, s50, 12
  s_add_u32 s20, s72, 0x0
  s_addc_u32 s21, s73, 0
  s_add_u32 s20, s20, s16
  s_addc_u32 s21, s21, 0
  s_mov_b32 s22, 0x1000
  s_mov_b32 s23, 0x20000
  s_lshl_b32 s17, s51, 11
  v_add_u32 v92, s17, v3
  v_subrev_u32 v93, 16, v92
  buffer_load_dwordx4 v[96:99], v93, s[20:23], 0 offen offset:0
  buffer_load_dwordx4 v[100:103], v92, s[20:23], 0 offen offset:0
  buffer_load_dwordx4 v[104:107], v93, s[20:23], 0 offen offset:1024
  buffer_load_dwordx4 v[108:111], v92, s[20:23], 0 offen offset:1024
  buffer_load_dwordx4 v[232:235], v9, s[28:31], 0 offen
  buffer_load_dwordx4 v[236:239], v10, s[28:31], 0 offen
  v_lshlrev_b32 v46, 11, v41
  s_lshl_b32 s32, s12, 7
  v_lshlrev_b32 v47, 4, v40
  v_add_u32 v47, s32, v47
  v_sub_u32 v47, 4080, v47
  v_add_u32 v47, v46, v47
  s_mov_b32 s28, s88
  s_mov_b32 s29, s89
  s_mov_b32 s30, 0x1c0000
  s_mov_b32 s31, 0x20000
  s_movk_i32 s33, 4096
  s_waitcnt vmcnt(6)
  v_lshlrev_b32 v56, 16, v36
  v_and_b32 v57, 0xffff0000, v36
  v_lshlrev_b32 v58, 16, v37
  v_and_b32 v59, 0xffff0000, v37
  v_lshlrev_b32 v60, 16, v38
  v_and_b32 v61, 0xffff0000, v38
  v_lshlrev_b32 v62, 16, v39
  v_and_b32 v63, 0xffff0000, v39
  v_lshlrev_b32 v64, 16, v16
  v_lshlrev_b32 v65, 16, v17
  v_lshlrev_b32 v66, 16, v18
  v_lshlrev_b32 v67, 16, v19
  v_lshlrev_b32 v68, 16, v20
  v_lshlrev_b32 v69, 16, v21
  v_lshlrev_b32 v70, 16, v22
  v_lshlrev_b32 v71, 16, v23
  v_lshlrev_b32 v72, 16, v24
  v_lshlrev_b32 v73, 16, v25
  v_lshlrev_b32 v74, 16, v26
  v_lshlrev_b32 v112, 16, v48
  v_lshlrev_b32 v113, 16, v49
  v_lshlrev_b32 v114, 16, v50
  v_lshlrev_b32 v115, 16, v51
  v_lshlrev_b32 v116, 16, v52
  v_lshlrev_b32 v117, 16, v53
  v_lshlrev_b32 v118, 16, v54
  v_lshlrev_b32 v119, 16, v55
  v_mul_f32 v76, v59, v64
  v_mul_f32 v77, v59, v65
  v_mul_f32 v78, v59, v66
  v_mul_f32 v79, v59, v67
  v_mul_f32 v80, v59, v68
  v_mul_f32 v81, v59, v69
  v_mul_f32 v82, v59, v70
  v_mul_f32 v83, v59, v71
  v_fmac_f32 v76, v58, v65
  v_fmac_f32 v77, v58, v66
  v_fmac_f32 v78, v58, v67
  v_fmac_f32 v79, v58, v68
  v_fmac_f32 v80, v58, v69
  v_fmac_f32 v81, v58, v70
  v_fmac_f32 v82, v58, v71
  v_fmac_f32 v83, v58, v72
  v_fmac_f32 v76, v57, v66
  v_fmac_f32 v77, v57, v67
  v_fmac_f32 v78, v57, v68
  v_fmac_f32 v79, v57, v69
  v_fmac_f32 v80, v57, v70
  v_fmac_f32 v81, v57, v71
  v_fmac_f32 v82, v57, v72
  v_fmac_f32 v83, v57, v73
  v_fmac_f32 v76, v56, v67
  v_fmac_f32 v77, v56, v68
  v_fmac_f32 v78, v56, v69
  v_fmac_f32 v79, v56, v70
  v_fmac_f32 v80, v56, v71
  v_fmac_f32 v81, v56, v72
  v_fmac_f32 v82, v56, v73
  v_fmac_f32 v83, v56, v74
  v_mul_f32 v76, v76, v112
  v_mul_f32 v77, v77, v113
  v_mul_f32 v78, v78, v114
  v_mul_f32 v79, v79, v115
  v_mul_f32 v80, v80, v116
  v_mul_f32 v81, v81, v117
  v_mul_f32 v82, v82, v118
  v_mul_f32 v83, v83, v119
  v_cvt_pk_bf16_f32 v84, v83, v82
  v_cvt_pk_bf16_f32 v85, v81, v80
  v_cvt_pk_bf16_f32 v86, v79, v78
  v_cvt_pk_bf16_f32 v87, v77, v76
  buffer_store_dwordx4 v[84:87], v47, s[28:31], 0 offen sc1
  v_and_b32 v64, 0xffff0000, v16
  v_and_b32 v65, 0xffff0000, v17
  v_and_b32 v66, 0xffff0000, v18
  v_and_b32 v67, 0xffff0000, v19
  v_and_b32 v68, 0xffff0000, v20
  v_and_b32 v69, 0xffff0000, v21
  v_and_b32 v70, 0xffff0000, v22
  v_and_b32 v71, 0xffff0000, v23
  v_and_b32 v72, 0xffff0000, v24
  v_and_b32 v73, 0xffff0000, v25
  v_and_b32 v74, 0xffff0000, v26
  v_and_b32 v112, 0xffff0000, v48
  v_and_b32 v113, 0xffff0000, v49
  v_and_b32 v114, 0xffff0000, v50
  v_and_b32 v115, 0xffff0000, v51
  v_and_b32 v116, 0xffff0000, v52
  v_and_b32 v117, 0xffff0000, v53
  v_and_b32 v118, 0xffff0000, v54
  v_and_b32 v119, 0xffff0000, v55
  v_mul_f32 v76, v63, v64
  v_mul_f32 v77, v63, v65
  v_mul_f32 v78, v63, v66
  v_mul_f32 v79, v63, v67
  v_mul_f32 v80, v63, v68
  v_mul_f32 v81, v63, v69
  v_mul_f32 v82, v63, v70
  v_mul_f32 v83, v63, v71
  v_fmac_f32 v76, v62, v65
  v_fmac_f32 v77, v62, v66
  v_fmac_f32 v78, v62, v67
  v_fmac_f32 v79, v62, v68
  v_fmac_f32 v80, v62, v69
  v_fmac_f32 v81, v62, v70
  v_fmac_f32 v82, v62, v71
  v_fmac_f32 v83, v62, v72
  v_fmac_f32 v76, v61, v66
  v_fmac_f32 v77, v61, v67
  v_fmac_f32 v78, v61, v68
  v_fmac_f32 v79, v61, v69
  v_fmac_f32 v80, v61, v70
  v_fmac_f32 v81, v61, v71
  v_fmac_f32 v82, v61, v72
  v_fmac_f32 v83, v61, v73
  v_fmac_f32 v76, v60, v67
  v_fmac_f32 v77, v60, v68
  v_fmac_f32 v78, v60, v69
  v_fmac_f32 v79, v60, v70
  v_fmac_f32 v80, v60, v71
  v_fmac_f32 v81, v60, v72
  v_fmac_f32 v82, v60, v73
  v_fmac_f32 v83, v60, v74
  v_mul_f32 v76, v76, v112
  v_mul_f32 v77, v77, v113
  v_mul_f32 v78, v78, v114
  v_mul_f32 v79, v79, v115
  v_mul_f32 v80, v80, v116
  v_mul_f32 v81, v81, v117
  v_mul_f32 v82, v82, v118
  v_mul_f32 v83, v83, v119
  v_cvt_pk_bf16_f32 v88, v83, v82
  v_cvt_pk_bf16_f32 v89, v81, v80
  v_cvt_pk_bf16_f32 v90, v79, v78
  v_cvt_pk_bf16_f32 v91, v77, v76
  buffer_store_dwordx4 v[88:91], v47, s[28:31], s33 offen sc1
  s_cmp_lg_u32 s3, 0
  s_cbranch_scc1 L_ii_3
  s_mov_b32 s56, s86
  s_mov_b32 s57, s87
  s_mov_b32 s58, 0x100
  s_mov_b32 s59, 0x20000
  v_mov_b32 v248, 0
  buffer_load_dword v249, v248, s[56:59], 0 offen sc1
L_ii_3:
  s_branch L_p0j_4
L_nokv_2:
  buffer_load_dwordx4 v[232:235], v9, s[28:31], 0 offen
  buffer_load_dwordx4 v[236:239], v10, s[28:31], 0 offen
L_p0j_4:
  s_cmp_ge_u32 s2, 224
  s_cbranch_scc1 L_s0skip_6
  s_waitcnt vmcnt(0)
  s_cmp_lg_u32 s3, 0
  s_cbranch_scc1 L_ic_7
  v_readfirstlane_b32 s61, v249
  s_nop 2
  s_cmp_lg_u32 s61, 0
  s_cbranch_scc1 L_ic_7
  s_cmp_lg_u32 s3, 0
  s_cbranch_scc1 L_wi_9
  s_mov_b32 s56, s86
  s_mov_b32 s57, s87
  s_mov_b32 s58, 0x100
  s_mov_b32 s59, 0x20000
  v_mov_b32 v250, 0
  s_mov_b64 exec, 1
  s_mov_b32 s61, 0
L_wip_10:
  buffer_load_dword v251, v250, s[56:59], 0 offen sc1
  s_add_u32 s61, s61, 1
  s_waitcnt vmcnt(0)
  v_cmp_ne_u32 vcc, 0, v251
  s_cmp_ge_u32 s61, 400000
  s_cbranch_scc1 L_wid_11
  s_nop 0
  s_cmp_eq_u64 vcc, exec
  s_cbranch_scc0 L_wip_10
L_wid_11:
  s_mov_b64 exec, -1
L_wi_9:
L_ic_7:
  s_barrier
  s_cmp_lg_u32 s3, 0
  s_cbranch_scc1 L_sig_12
  v_lshlrev_b32 v250, 7, v2
  s_lshl_b32 s60, s62, 7
  v_add_u32 v250, s60, v250
  v_mov_b32 v251, 1
  s_mov_b64 exec, 1
  buffer_atomic_add v251, v250, s[92:95], 0 offen sc1
  s_mov_b64 exec, -1
L_sig_12:
  s_cmp_lg_u32 s3, 3
  s_cbranch_scc1 L_tk_13
  s_getreg_b32 s98, hwreg(HW_REG_XCC_ID, 0, 4)
  s_and_b32 s98, s98, 7
  s_add_u32 s12, s98, 24
  s_lshl_b32 s12, s12, 7
  v_mov_b32 v244, s12
  v_mov_b32 v245, 1
  s_mov_b64 exec, 1
  buffer_atomic_add v245, v244, s[92:95], 0 offen sc0 sc1
  s_mov_b64 exec, -1
L_tk_13:
  v_lshrrev_b32 v62, 2, v2
  v_and_b32 v63, 3, v2
  v_lshlrev_b32 v63, 4, v63
  v_mul_u32_u24 v60, 3584, v62
  v_add_u32 v60, v60, v63
  v_mul_u32_u24 v61, 896, v62
  v_add_u32 v61, v61, v63
  s_mov_b32 s12, s48
  s_mul_i32 s13, s3, 5120
  s_add_u32 s13, s13, 100352
  s_mov_b32 m0, s13
  s_mul_hi_u32 s14, s12, 0x4924925
  s_mul_i32 s15, s14, 56
  s_sub_u32 s15, s12, s15
  s_lshr_b32 s28, s15, 1
  s_mul_i32 s28, s28, 16*3584
  s_lshl_b32 s29, s14, 6
  s_add_u32 s28, s28, s29
  s_and_b32 s15, s15, 1
  s_cmp_eq_u32 s15, 0
  s_cselect_b32 s16, s78, s80
  s_cselect_b32 s17, s79, s81
  s_mov_b32 s18, 0x188000
  s_mov_b32 s19, 0x20000
  buffer_load_dwordx4 v60, s[16:19], s28 offen lds
  s_lshl_b32 s40, s12, 10
  s_mov_b32 s34, 0
  s_add_u32 s12, s48, 1024
  s_mul_i32 s13, s3, 5120
  s_add_u32 s13, s13, 101376
  s_mov_b32 m0, s13
  s_mul_hi_u32 s14, s12, 0x4924925
  s_mul_i32 s15, s14, 56
  s_sub_u32 s15, s12, s15
  s_lshr_b32 s28, s15, 1
  s_mul_i32 s28, s28, 16*3584
  s_lshl_b32 s29, s14, 6
  s_add_u32 s28, s28, s29
  s_and_b32 s15, s15, 1
  s_cmp_eq_u32 s15, 0
  s_cselect_b32 s16, s78, s80
  s_cselect_b32 s17, s79, s81
  s_mov_b32 s18, 0x188000
  s_mov_b32 s19, 0x20000
  buffer_load_dwordx4 v60, s[16:19], s28 offen lds
  s_lshl_b32 s41, s12, 10
  s_mov_b32 s35, 0
  s_add_u32 s12, s48, 2048
  s_mul_i32 s13, s3, 5120
  s_add_u32 s13, s13, 102400
  s_mov_b32 m0, s13
  s_mul_hi_u32 s14, s12, 0x4924925
  s_mul_i32 s15, s14, 56
  s_sub_u32 s15, s12, s15
  s_lshr_b32 s28, s15, 1
  s_mul_i32 s28, s28, 16*3584
  s_lshl_b32 s29, s14, 6
  s_add_u32 s28, s28, s29
  s_and_b32 s15, s15, 1
  s_cmp_eq_u32 s15, 0
  s_cselect_b32 s16, s78, s80
  s_cselect_b32 s17, s79, s81
  s_mov_b32 s18, 0x188000
  s_mov_b32 s19, 0x20000
  buffer_load_dwordx4 v60, s[16:19], s28 offen lds
  s_lshl_b32 s42, s12, 10
  s_mov_b32 s36, 0
  s_mov_b32 s12, s48
  s_mul_i32 s13, s3, 5120
  s_add_u32 s13, s13, 103424
  s_mov_b32 m0, s13
  s_mul_hi_u32 s14, s12, 0x2492493
  s_mul_i32 s15, s14, 112
  s_sub_u32 s15, s12, s15
  s_mul_i32 s28, s15, 16*896
  s_lshl_b32 s29, s14, 6
  s_add_u32 s28, s28, s29
  s_mov_b32 s16, s82
  s_mov_b32 s17, s83
  s_mov_b32 s18, 0x188000
  s_mov_b32 s19, 0x20000
  buffer_load_dwordx4 v61, s[16:19], s28 offen lds
  s_lshl_b32 s43, s12, 10
  s_mov_b32 s37, 1
  s_mov_b32 s38, 2
  s_cmp_ge_u32 s48, 608
  s_cbranch_scc1 L_w4s_15
  s_cmp_ge_u32 s48, 544
  s_cbranch_scc1 L_w4g_14
  s_add_u32 s12, s48, 1024
  s_mul_i32 s13, s3, 5120
  s_add_u32 s13, s13, 104448
  s_mov_b32 m0, s13
  s_mul_hi_u32 s14, s12, 0x2492493
  s_mul_i32 s15, s14, 112
  s_sub_u32 s15, s12, s15
  s_mul_i32 s28, s15, 16*896
  s_lshl_b32 s29, s14, 6
  s_add_u32 s28, s28, s29
  s_mov_b32 s16, s82
  s_mov_b32 s17, s83
  s_mov_b32 s18, 0x188000
  s_mov_b32 s19, 0x20000
  buffer_load_dwordx4 v61, s[16:19], s28 offen lds
  s_lshl_b32 s44, s12, 10
  s_mov_b32 s38, 1
  s_branch L_w4d_16
L_w4g_14:
  s_add_u32 s12, s48, 3072-544
  s_mul_i32 s13, s3, 5120
  s_add_u32 s13, s13, 104448
  s_mov_b32 m0, s13
  s_mul_hi_u32 s14, s12, 0x4924925
  s_mul_i32 s15, s14, 56
  s_sub_u32 s15, s12, s15
  s_lshr_b32 s28, s15, 1
  s_mul_i32 s28, s28, 16*3584
  s_lshl_b32 s29, s14, 6
  s_add_u32 s28, s28, s29
  s_and_b32 s15, s15, 1
  s_cmp_eq_u32 s15, 0
  s_cselect_b32 s16, s78, s80
  s_cselect_b32 s17, s79, s81
  s_mov_b32 s18, 0x188000
  s_mov_b32 s19, 0x20000
  buffer_load_dwordx4 v60, s[16:19], s28 offen lds
  s_lshl_b32 s44, s12, 10
  s_mov_b32 s38, 0
  s_branch L_w4d_16
L_w4s_15:
  s_mul_i32 s13, s3, 5120
  s_add_u32 s13, s13, 104448
  s_mov_b32 m0, s13
  s_mov_b32 s16, s82
  s_mov_b32 s17, s83
  s_mov_b32 s18, 0x0
  s_mov_b32 s19, 0x20000
  buffer_load_dwordx4 v61, s[16:19], 0 offen lds
  s_mov_b32 s44, 0x7ff00000
L_w4d_16:
  v_add_u32 v6, s52, v92
  v_add_u32 v6, 16, v6
  v_mov_b32 v8, 0
  v_mov_b32 v9, 0
  v_mov_b32 v10, 0
  v_mov_b32 v11, 0
  s_cmp_eq_u32 s51, 0
  s_cbranch_scc0 L_cz_17
  v_mul_u32_u24 v7, 4160, v2
  v_add_u32 v7, s52, v7
  v_cmp_gt_u32 vcc, 8, v2
  s_nop 2
  s_and_saveexec_b64 s[30:31], vcc
  ds_write_b128 v7, v[8:11]
  s_mov_b64 exec, s[30:31]
  s_branch L_cz_18
L_cz_17:
  v_add_u32 v7, s52, v3
  v_add_u32 v7, 37376, v7
  v_cmp_gt_u32 vcc, 30, v2
  s_nop 2
  s_and_saveexec_b64 s[30:31], vcc
  ds_write_b128 v7, v[8:11]
  s_mov_b64 exec, s[30:31]
L_cz_18:
  v_alignbit_b32 v16, v97, v96, 16
  v_alignbit_b32 v17, v98, v97, 16
  v_alignbit_b32 v18, v99, v98, 16
  v_alignbit_b32 v19, v100, v99, 16
  ds_write_b128 v6, v[16:19] offset:0
  v_mov_b32 v20, v97
  v_mov_b32 v21, v98
  v_mov_b32 v22, v99
  v_mov_b32 v23, v100
  ds_write_b128 v6, v[20:23] offset:4160
  v_alignbit_b32 v24, v98, v97, 16
  v_alignbit_b32 v25, v99, v98, 16
  v_alignbit_b32 v26, v100, v99, 16
  v_alignbit_b32 v27, v101, v100, 16
  ds_write_b128 v6, v[24:27] offset:8320
  ds_write_b128 v6, v[98:101] offset:12480
  v_alignbit_b32 v16, v99, v98, 16
  v_alignbit_b32 v17, v100, v99, 16
  v_alignbit_b32 v18, v101, v100, 16
  v_alignbit_b32 v19, v102, v101, 16
  ds_write_b128 v6, v[16:19] offset:16640
  v_mov_b32 v20, v99
  v_mov_b32 v21, v100
  v_mov_b32 v22, v101
  v_mov_b32 v23, v102
  ds_write_b128 v6, v[20:23] offset:20800
  v_alignbit_b32 v24, v100, v99, 16
  v_alignbit_b32 v25, v101, v100, 16
  v_alignbit_b32 v26, v102, v101, 16
  v_alignbit_b32 v27, v103, v102, 16
  ds_write_b128 v6, v[24:27] offset:24960
  ds_write_b128 v6, v[100:103] offset:29120
  v_alignbit_b32 v32, v105, v104, 16
  v_alignbit_b32 v33, v106, v105, 16
  v_alignbit_b32 v34, v107, v106, 16
  v_alignbit_b32 v35, v108, v107, 16
  ds_write_b128 v6, v[32:35] offset:1024
  v_mov_b32 v36, v105
  v_mov_b32 v37, v106
  v_mov_b32 v38, v107
  v_mov_b32 v39, v108
  ds_write_b128 v6, v[36:39] offset:5184
  v_alignbit_b32 v40, v106, v105, 16
  v_alignbit_b32 v41, v107, v106, 16
  v_alignbit_b32 v42, v108, v107, 16
  v_alignbit_b32 v43, v109, v108, 16
  ds_write_b128 v6, v[40:43] offset:9344
  ds_write_b128 v6, v[106:109] offset:13504
  v_alignbit_b32 v32, v107, v106, 16
  v_alignbit_b32 v33, v108, v107, 16
  v_alignbit_b32 v34, v109, v108, 16
  v_alignbit_b32 v35, v110, v109, 16
  ds_write_b128 v6, v[32:35] offset:17664
  v_mov_b32 v36, v107
  v_mov_b32 v37, v108
  v_mov_b32 v38, v109
  v_mov_b32 v39, v110
  ds_write_b128 v6, v[36:39] offset:21824
  v_alignbit_b32 v40, v108, v107, 16
  v_alignbit_b32 v41, v109, v108, 16
  v_alignbit_b32 v42, v110, v109, 16
  v_alignbit_b32 v43, v111, v110, 16
  ds_write_b128 v6, v[40:43] offset:25984
  ds_write_b128 v6, v[108:111] offset:30144
  s_cmp_lg_u32 s3, 0
  s_cbranch_scc1 L_wt_19
  v_lshlrev_b32 v250, 7, v2
  s_lshl_b32 s60, s62, 7
  v_add_u32 v250, s60, v250
  s_mov_b64 exec, 1
  s_mov_b32 s61, 0
L_pl_20:
  buffer_load_dword v251, v250, s[92:95], 0 offen sc1
  s_add_u32 s61, s61, 1
  s_waitcnt vmcnt(0)
  v_cmp_le_u32 vcc, 32, v251
  s_nop 2
  s_cmp_eq_u64 vcc, exec
  s_cbranch_scc1 L_pd_21
  s_sleep 6
  s_cmp_lt_u32 s61, 400000
  s_cbranch_scc1 L_pl_20
L_pd_21:
  s_mov_b64 exec, -1
L_wt_19:
  s_barrier
  s_mov_b32 s16, s88
  s_mov_b32 s17, s89
  s_mov_b32 s18, 0x1c0000
  s_mov_b32 s19, 0x20000
  s_add_u32 s24, s88, 0x200000
  s_addc_u32 s25, s89, 0
  s_mov_b32 s26, 0x1c0000
  s_mov_b32 s27, 0x20000
  s_lshl_b32 s20, s50, 12
  s_lshl_b32 s21, s51, 11
  s_add_u32 s20, s20, s21
  buffer_load_dwordx4 v[16:19], v3, s[16:19], s20 offen sc1
  buffer_load_dwordx4 v[20:23], v3, s[16:19], s20 offen offset:1024 sc1
  s_and_b32 s28, s50, 0xfffffffe
  s_lshl_b32 s28, s28, 1
  s_load_dword s29, s[74:75], s28
  s_add_u32 s21, s21, s52
  s_add_u32 s21, s21, 33280
  v_add_u32 v4, s21, v3
  v_and_b32 v5, 15, v2
  v_lshrrev_b32 v6, 4, v2
  v_lshlrev_b32 v7, 4, v6
  v_lshlrev_b32 v8, 5, v5
  v_sub_u32 v7, v7, v8
  s_lshl_b32 s22, s51, 6
  s_add_u32 s22, s22, s52
  s_add_u32 s22, s22, 33760
  v_add_u32 v7, s22, v7
  v_and_b32 v12, 7, v5
  v_mul_u32_u24 v12, 4160, v12
  v_lshrrev_b32 v13, 3, v5
  v_add_u32 v13, v6, v13
  v_lshlrev_b32 v13, 4, v13
  v_add_u32 v12, v12, v13
  s_lshl_b32 s22, s51, 6
  s_add_u32 s22, s22, s52
  v_add_u32 v12, s22, v12
  s_waitcnt vmcnt(2)
  v_and_b32 v62, 15, v2
  v_lshrrev_b32 v63, 4, v2
  v_lshrrev_b32 v64, 2, v62
  v_and_b32 v65, 3, v62
  v_lshlrev_b32 v65, 3, v65
  v_and_b32 v66, 1, v63
  v_lshl_add_u32 v65, v66, 5, v65
  v_lshl_add_u32 v65, v64, 6, v65
  v_lshrrev_b32 v63, 1, v63
  s_mul_i32 s13, s3, 5120
  s_add_u32 s13, s13, 100352
  v_add_u32 v65, s13, v65
  v_lshl_add_u32 v66, v63, 9, v65
  v_lshl_add_u32 v67, v63, 8, v65
  ds_read_b64_tr_b16 v[112:113], v66 offset:0
  ds_read_b64_tr_b16 v[114:115], v66 offset:256
  ds_read_b64_tr_b16 v[116:117], v66 offset:1024
  ds_read_b64_tr_b16 v[118:119], v66 offset:1280
  ds_read_b64_tr_b16 v[120:121], v66 offset:2048
  ds_read_b64_tr_b16 v[122:123], v66 offset:2304
  ds_read_b64_tr_b16 v[124:125], v67 offset:3072
  ds_read_b64_tr_b16 v[126:127], v67 offset:3584
  s_cmp_eq_u32 s38, 1
  s_cbranch_scc1 L_trw_30
  ds_read_b64_tr_b16 v[128:129], v66 offset:4096
  ds_read_b64_tr_b16 v[130:131], v66 offset:4352
  s_branch L_tre_31
L_trw_30:
  ds_read_b64_tr_b16 v[128:129], v67 offset:4096
  ds_read_b64_tr_b16 v[130:131], v67 offset:4608
L_tre_31:
  s_waitcnt lgkmcnt(0)
  buffer_store_dwordx4 v[112:115], v3, s[4:7], s40 offen sc1
  buffer_store_dwordx4 v[116:119], v3, s[4:7], s41 offen sc1
  buffer_store_dwordx4 v[120:123], v3, s[4:7], s42 offen sc1
  buffer_store_dwordx4 v[124:127], v3, s[8:11], s43 offen sc1
  s_cmp_eq_u32 s38, 1
  s_cbranch_scc1 L_stw_32
  buffer_store_dwordx4 v[128:131], v3, s[4:7], s44 offen sc1
  s_branch L_ste_33
L_stw_32:
  buffer_store_dwordx4 v[128:131], v3, s[8:11], s44 offen sc1
L_ste_33:
  s_waitcnt vmcnt(5)
  ds_write_b128 v4, v[16:19]
  ds_write_b128 v4, v[20:23] offset:1024
  s_waitcnt lgkmcnt(0)
  s_barrier
  ds_read_b128 v[176:179], v12 offset:3968
  ds_read_b128 v[48:51], v7 offset:3968
  ds_read_b128 v[180:183], v12 offset:3840
  ds_read_b128 v[52:55], v7 offset:3840
  ds_read_b128 v[184:187], v12 offset:3712
  ds_read_b128 v[56:59], v7 offset:3712
  ds_read_b128 v[188:191], v12 offset:3584
  ds_read_b128 v[60:63], v7 offset:3584
  ds_read_b128 v[192:195], v12 offset:3456
  ds_read_b128 v[64:67], v7 offset:3456
  s_waitcnt lgkmcnt(8)
  v_mfma_f32_16x16x32_bf16 v[44:47], v[176:179], v[48:51], 0
  ds_read_b128 v[196:199], v12 offset:3328
  ds_read_b128 v[68:71], v7 offset:3328
  s_waitcnt lgkmcnt(8)
  v_mfma_f32_16x16x32_bf16 v[44:47], v[180:183], v[52:55], v[44:47]
  ds_read_b128 v[200:203], v12 offset:3200
  ds_read_b128 v[72:75], v7 offset:3200
  s_waitcnt lgkmcnt(8)
  v_mfma_f32_16x16x32_bf16 v[44:47], v[184:187], v[56:59], v[44:47]
  ds_read_b128 v[204:207], v12 offset:3072
  ds_read_b128 v[76:79], v7 offset:3072
  s_waitcnt lgkmcnt(8)
  v_mfma_f32_16x16x32_bf16 v[44:47], v[188:191], v[60:63], v[44:47]
  ds_read_b128 v[176:179], v12 offset:2944
  ds_read_b128 v[80:83], v7 offset:2944
  s_waitcnt lgkmcnt(8)
  v_mfma_f32_16x16x32_bf16 v[40:43], v[192:195], v[48:51], 0
  v_mfma_f32_16x16x32_bf16 v[44:47], v[192:195], v[64:67], v[44:47]
  ds_read_b128 v[180:183], v12 offset:2816
  ds_read_b128 v[84:87], v7 offset:2816
  s_waitcnt lgkmcnt(8)
  v_mfma_f32_16x16x32_bf16 v[40:43], v[196:199], v[52:55], v[40:43]
  v_mfma_f32_16x16x32_bf16 v[44:47], v[196:199], v[68:71], v[44:47]
  ds_read_b128 v[184:187], v12 offset:2688
  ds_read_b128 v[88:91], v7 offset:2688
  s_waitcnt lgkmcnt(8)
  v_mfma_f32_16x16x32_bf16 v[40:43], v[200:203], v[56:59], v[40:43]
  v_mfma_f32_16x16x32_bf16 v[44:47], v[200:203], v[72:75], v[44:47]
  ds_read_b128 v[188:191], v12 offset:2560
  ds_read_b128 v[92:95], v7 offset:2560
  s_waitcnt lgkmcnt(8)
  v_mfma_f32_16x16x32_bf16 v[40:43], v[204:207], v[60:63], v[40:43]
  v_mfma_f32_16x16x32_bf16 v[44:47], v[204:207], v[76:79], v[44:47]
  ds_read_b128 v[192:195], v12 offset:2432
  ds_read_b128 v[96:99], v7 offset:2432
  s_waitcnt lgkmcnt(8)
  v_mfma_f32_16x16x32_bf16 v[36:39], v[176:179], v[48:51], 0
  v_mfma_f32_16x16x32_bf16 v[40:43], v[176:179], v[64:67], v[40:43]
  v_mfma_f32_16x16x32_bf16 v[44:47], v[176:179], v[80:83], v[44:47]
  ds_read_b128 v[196:199], v12 offset:2304
  ds_read_b128 v[100:103], v7 offset:2304
  s_waitcnt lgkmcnt(8)
  v_mfma_f32_16x16x32_bf16 v[36:39], v[180:183], v[52:55], v[36:39]
  v_mfma_f32_16x16x32_bf16 v[40:43], v[180:183], v[68:71], v[40:43]
  v_mfma_f32_16x16x32_bf16 v[44:47], v[180:183], v[84:87], v[44:47]
  ds_read_b128 v[200:203], v12 offset:2176
  ds_read_b128 v[104:107], v7 offset:2176
  s_waitcnt lgkmcnt(8)
  v_mfma_f32_16x16x32_bf16 v[36:39], v[184:187], v[56:59], v[36:39]
  v_mfma_f32_16x16x32_bf16 v[40:43], v[184:187], v[72:75], v[40:43]
  v_mfma_f32_16x16x32_bf16 v[44:47], v[184:187], v[88:91], v[44:47]
  ds_read_b128 v[204:207], v12 offset:2048
  ds_read_b128 v[108:111], v7 offset:2048
  s_waitcnt lgkmcnt(8)
  v_mfma_f32_16x16x32_bf16 v[36:39], v[188:191], v[60:63], v[36:39]
  v_mfma_f32_16x16x32_bf16 v[40:43], v[188:191], v[76:79], v[40:43]
  v_mfma_f32_16x16x32_bf16 v[44:47], v[188:191], v[92:95], v[44:47]
  ds_read_b128 v[176:179], v12 offset:1920
  ds_read_b128 v[112:115], v7 offset:1920
  s_waitcnt lgkmcnt(8)
  v_mfma_f32_16x16x32_bf16 v[32:35], v[192:195], v[48:51], 0
  v_mfma_f32_16x16x32_bf16 v[36:39], v[192:195], v[64:67], v[36:39]
  v_mfma_f32_16x16x32_bf16 v[40:43], v[192:195], v[80:83], v[40:43]
  v_mfma_f32_16x16x32_bf16 v[44:47], v[192:195], v[96:99], v[44:47]
  ds_read_b128 v[180:183], v12 offset:1792
  ds_read_b128 v[116:119], v7 offset:1792
  s_waitcnt lgkmcnt(8)
  v_mfma_f32_16x16x32_bf16 v[32:35], v[196:199], v[52:55], v[32:35]
  v_mfma_f32_16x16x32_bf16 v[36:39], v[196:199], v[68:71], v[36:39]
  v_mfma_f32_16x16x32_bf16 v[40:43], v[196:199], v[84:87], v[40:43]
  v_mfma_f32_16x16x32_bf16 v[44:47], v[196:199], v[100:103], v[44:47]
  ds_read_b128 v[184:187], v12 offset:1664
  ds_read_b128 v[120:123], v7 offset:1664
  s_waitcnt lgkmcnt(8)
  v_mfma_f32_16x16x32_bf16 v[32:35], v[200:203], v[56:59], v[32:35]
  v_mfma_f32_16x16x32_bf16 v[36:39], v[200:203], v[72:75], v[36:39]
  v_mfma_f32_16x16x32_bf16 v[40:43], v[200:203], v[88:91], v[40:43]
  v_mfma_f32_16x16x32_bf16 v[44:47], v[200:203], v[104:107], v[44:47]
  ds_read_b128 v[188:191], v12 offset:1536
  ds_read_b128 v[124:127], v7 offset:1536
  s_waitcnt lgkmcnt(8)
  v_mfma_f32_16x16x32_bf16 v[32:35], v[204:207], v[60:63], v[32:35]
  v_mfma_f32_16x16x32_bf16 v[36:39], v[204:207], v[76:79], v[36:39]
  v_mfma_f32_16x16x32_bf16 v[40:43], v[204:207], v[92:95], v[40:43]
  v_mfma_f32_16x16x32_bf16 v[44:47], v[204:207], v[108:111], v[44:47]
  ds_read_b128 v[192:195], v12 offset:1408
  ds_read_b128 v[128:131], v7 offset:1408
  s_waitcnt lgkmcnt(8)
  v_mfma_f32_16x16x32_bf16 v[28:31], v[176:179], v[48:51], 0
  v_mfma_f32_16x16x32_bf16 v[32:35], v[176:179], v[64:67], v[32:35]
  v_mfma_f32_16x16x32_bf16 v[36:39], v[176:179], v[80:83], v[36:39]
  v_mfma_f32_16x16x32_bf16 v[40:43], v[176:179], v[96:99], v[40:43]
  v_mfma_f32_16x16x32_bf16 v[44:47], v[176:179], v[112:115], v[44:47]
  ds_read_b128 v[196:199], v12 offset:1280
  ds_read_b128 v[132:135], v7 offset:1280
  s_waitcnt lgkmcnt(8)
  v_mfma_f32_16x16x32_bf16 v[28:31], v[180:183], v[52:55], v[28:31]
  v_mfma_f32_16x16x32_bf16 v[32:35], v[180:183], v[68:71], v[32:35]
  v_mfma_f32_16x16x32_bf16 v[36:39], v[180:183], v[84:87], v[36:39]
  v_mfma_f32_16x16x32_bf16 v[40:43], v[180:183], v[100:103], v[40:43]
  v_mfma_f32_16x16x32_bf16 v[44:47], v[180:183], v[116:119], v[44:47]
  ds_read_b128 v[200:203], v12 offset:1152
  ds_read_b128 v[136:139], v7 offset:1152
  s_waitcnt lgkmcnt(8)
  v_mfma_f32_16x16x32_bf16 v[28:31], v[184:187], v[56:59], v[28:31]
  v_mfma_f32_16x16x32_bf16 v[32:35], v[184:187], v[72:75], v[32:35]
  v_mfma_f32_16x16x32_bf16 v[36:39], v[184:187], v[88:91], v[36:39]
  v_mfma_f32_16x16x32_bf16 v[40:43], v[184:187], v[104:107], v[40:43]
  v_mfma_f32_16x16x32_bf16 v[44:47], v[184:187], v[120:123], v[44:47]
  ds_read_b128 v[204:207], v12 offset:1024
  ds_read_b128 v[140:143], v7 offset:1024
  s_waitcnt lgkmcnt(8)
  v_mfma_f32_16x16x32_bf16 v[28:31], v[188:191], v[60:63], v[28:31]
  v_mfma_f32_16x16x32_bf16 v[32:35], v[188:191], v[76:79], v[32:35]
  v_mfma_f32_16x16x32_bf16 v[36:39], v[188:191], v[92:95], v[36:39]
  v_mfma_f32_16x16x32_bf16 v[40:43], v[188:191], v[108:111], v[40:43]
  v_mfma_f32_16x16x32_bf16 v[44:47], v[188:191], v[124:127], v[44:47]
  ds_read_b128 v[176:179], v12 offset:896
  ds_read_b128 v[144:147], v7 offset:896
  s_waitcnt lgkmcnt(8)
  v_mfma_f32_16x16x32_bf16 v[24:27], v[192:195], v[48:51], 0
  v_mfma_f32_16x16x32_bf16 v[28:31], v[192:195], v[64:67], v[28:31]
  v_mfma_f32_16x16x32_bf16 v[32:35], v[192:195], v[80:83], v[32:35]
  v_mfma_f32_16x16x32_bf16 v[36:39], v[192:195], v[96:99], v[36:39]
  v_mfma_f32_16x16x32_bf16 v[40:43], v[192:195], v[112:115], v[40:43]
  v_mfma_f32_16x16x32_bf16 v[44:47], v[192:195], v[128:131], v[44:47]
  ds_read_b128 v[180:183], v12 offset:768
  ds_read_b128 v[148:151], v7 offset:768
  s_waitcnt lgkmcnt(8)
  v_mfma_f32_16x16x32_bf16 v[24:27], v[196:199], v[52:55], v[24:27]
  v_mfma_f32_16x16x32_bf16 v[28:31], v[196:199], v[68:71], v[28:31]
  v_mfma_f32_16x16x32_bf16 v[32:35], v[196:199], v[84:87], v[32:35]
  v_mfma_f32_16x16x32_bf16 v[36:39], v[196:199], v[100:103], v[36:39]
  v_mfma_f32_16x16x32_bf16 v[40:43], v[196:199], v[116:119], v[40:43]
  v_mfma_f32_16x16x32_bf16 v[44:47], v[196:199], v[132:135], v[44:47]
  ds_read_b128 v[184:187], v12 offset:640
  ds_read_b128 v[152:155], v7 offset:640
  s_waitcnt lgkmcnt(8)
  v_mfma_f32_16x16x32_bf16 v[24:27], v[200:203], v[56:59], v[24:27]
  v_mfma_f32_16x16x32_bf16 v[28:31], v[200:203], v[72:75], v[28:31]
  v_mfma_f32_16x16x32_bf16 v[32:35], v[200:203], v[88:91], v[32:35]
  v_mfma_f32_16x16x32_bf16 v[36:39], v[200:203], v[104:107], v[36:39]
  v_mfma_f32_16x16x32_bf16 v[40:43], v[200:203], v[120:123], v[40:43]
  v_mfma_f32_16x16x32_bf16 v[44:47], v[200:203], v[136:139], v[44:47]
  ds_read_b128 v[188:191], v12 offset:512
  ds_read_b128 v[156:159], v7 offset:512
  s_waitcnt lgkmcnt(8)
  v_mfma_f32_16x16x32_bf16 v[24:27], v[204:207], v[60:63], v[24:27]
  v_mfma_f32_16x16x32_bf16 v[28:31], v[204:207], v[76:79], v[28:31]
  v_mfma_f32_16x16x32_bf16 v[32:35], v[204:207], v[92:95], v[32:35]
  v_mfma_f32_16x16x32_bf16 v[36:39], v[204:207], v[108:111], v[36:39]
  v_mfma_f32_16x16x32_bf16 v[40:43], v[204:207], v[124:127], v[40:43]
  v_mfma_f32_16x16x32_bf16 v[44:47], v[204:207], v[140:143], v[44:47]
  ds_read_b128 v[192:195], v12 offset:384
  ds_read_b128 v[160:163], v7 offset:384
  s_waitcnt lgkmcnt(8)
  v_mfma_f32_16x16x32_bf16 v[20:23], v[176:179], v[48:51], 0
  v_mfma_f32_16x16x32_bf16 v[24:27], v[176:179], v[64:67], v[24:27]
  v_mfma_f32_16x16x32_bf16 v[28:31], v[176:179], v[80:83], v[28:31]
  v_mfma_f32_16x16x32_bf16 v[32:35], v[176:179], v[96:99], v[32:35]
  v_mfma_f32_16x16x32_bf16 v[36:39], v[176:179], v[112:115], v[36:39]
  v_mfma_f32_16x16x32_bf16 v[40:43], v[176:179], v[128:131], v[40:43]
  v_mfma_f32_16x16x32_bf16 v[44:47], v[176:179], v[144:147], v[44:47]
  ds_read_b128 v[196:199], v12 offset:256
  ds_read_b128 v[164:167], v7 offset:256
  s_waitcnt lgkmcnt(8)
  v_mfma_f32_16x16x32_bf16 v[20:23], v[180:183], v[52:55], v[20:23]
  v_mfma_f32_16x16x32_bf16 v[24:27], v[180:183], v[68:71], v[24:27]
  v_mfma_f32_16x16x32_bf16 v[28:31], v[180:183], v[84:87], v[28:31]
  v_mfma_f32_16x16x32_bf16 v[32:35], v[180:183], v[100:103], v[32:35]
  v_mfma_f32_16x16x32_bf16 v[36:39], v[180:183], v[116:119], v[36:39]
  v_mfma_f32_16x16x32_bf16 v[40:43], v[180:183], v[132:135], v[40:43]
  v_mfma_f32_16x16x32_bf16 v[44:47], v[180:183], v[148:151], v[44:47]
  ds_read_b128 v[200:203], v12 offset:128
  ds_read_b128 v[168:171], v7 offset:128
  s_waitcnt lgkmcnt(8)
  v_mfma_f32_16x16x32_bf16 v[20:23], v[184:187], v[56:59], v[20:23]
  v_mfma_f32_16x16x32_bf16 v[24:27], v[184:187], v[72:75], v[24:27]
  v_mfma_f32_16x16x32_bf16 v[28:31], v[184:187], v[88:91], v[28:31]
  v_mfma_f32_16x16x32_bf16 v[32:35], v[184:187], v[104:107], v[32:35]
  v_mfma_f32_16x16x32_bf16 v[36:39], v[184:187], v[120:123], v[36:39]
  v_mfma_f32_16x16x32_bf16 v[40:43], v[184:187], v[136:139], v[40:43]
  v_mfma_f32_16x16x32_bf16 v[44:47], v[184:187], v[152:155], v[44:47]
  ds_read_b128 v[204:207], v12 offset:0
  ds_read_b128 v[172:175], v7 offset:0
  s_waitcnt lgkmcnt(8)
  v_mfma_f32_16x16x32_bf16 v[20:23], v[188:191], v[60:63], v[20:23]
  v_mfma_f32_16x16x32_bf16 v[24:27], v[188:191], v[76:79], v[24:27]
  v_mfma_f32_16x16x32_bf16 v[28:31], v[188:191], v[92:95], v[28:31]
  v_mfma_f32_16x16x32_bf16 v[32:35], v[188:191], v[108:111], v[32:35]
  v_mfma_f32_16x16x32_bf16 v[36:39], v[188:191], v[124:127], v[36:39]
  v_mfma_f32_16x16x32_bf16 v[40:43], v[188:191], v[140:143], v[40:43]
  v_mfma_f32_16x16x32_bf16 v[44:47], v[188:191], v[156:159], v[44:47]
  s_waitcnt lgkmcnt(6)
  v_mfma_f32_16x16x32_bf16 v[16:19], v[192:195], v[48:51], 0
  v_mfma_f32_16x16x32_bf16 v[20:23], v[192:195], v[64:67], v[20:23]
  v_mfma_f32_16x16x32_bf16 v[24:27], v[192:195], v[80:83], v[24:27]
  v_mfma_f32_16x16x32_bf16 v[28:31], v[192:195], v[96:99], v[28:31]
  v_mfma_f32_16x16x32_bf16 v[32:35], v[192:195], v[112:115], v[32:35]
  v_mfma_f32_16x16x32_bf16 v[36:39], v[192:195], v[128:131], v[36:39]
  v_mfma_f32_16x16x32_bf16 v[40:43], v[192:195], v[144:147], v[40:43]
  v_mfma_f32_16x16x32_bf16 v[44:47], v[192:195], v[160:163], v[44:47]
  s_waitcnt lgkmcnt(4)
  v_mfma_f32_16x16x32_bf16 v[16:19], v[196:199], v[52:55], v[16:19]
  v_mfma_f32_16x16x32_bf16 v[20:23], v[196:199], v[68:71], v[20:23]
  v_mfma_f32_16x16x32_bf16 v[24:27], v[196:199], v[84:87], v[24:27]
  v_mfma_f32_16x16x32_bf16 v[28:31], v[196:199], v[100:103], v[28:31]
  v_mfma_f32_16x16x32_bf16 v[32:35], v[196:199], v[116:119], v[32:35]
  v_mfma_f32_16x16x32_bf16 v[36:39], v[196:199], v[132:135], v[36:39]
  v_mfma_f32_16x16x32_bf16 v[40:43], v[196:199], v[148:151], v[40:43]
  v_mfma_f32_16x16x32_bf16 v[44:47], v[196:199], v[164:167], v[44:47]
  s_waitcnt lgkmcnt(2)
  v_mfma_f32_16x16x32_bf16 v[16:19], v[200:203], v[56:59], v[16:19]
  v_mfma_f32_16x16x32_bf16 v[20:23], v[200:203], v[72:75], v[20:23]
  v_mfma_f32_16x16x32_bf16 v[24:27], v[200:203], v[88:91], v[24:27]
  v_mfma_f32_16x16x32_bf16 v[28:31], v[200:203], v[104:107], v[28:31]
  v_mfma_f32_16x16x32_bf16 v[32:35], v[200:203], v[120:123], v[32:35]
  v_mfma_f32_16x16x32_bf16 v[36:39], v[200:203], v[136:139], v[36:39]
  v_mfma_f32_16x16x32_bf16 v[40:43], v[200:203], v[152:155], v[40:43]
  v_mfma_f32_16x16x32_bf16 v[44:47], v[200:203], v[168:171], v[44:47]
  s_waitcnt lgkmcnt(0)
  v_mfma_f32_16x16x32_bf16 v[16:19], v[204:207], v[60:63], v[16:19]
  v_mfma_f32_16x16x32_bf16 v[20:23], v[204:207], v[76:79], v[20:23]
  v_mfma_f32_16x16x32_bf16 v[24:27], v[204:207], v[92:95], v[24:27]
  v_mfma_f32_16x16x32_bf16 v[28:31], v[204:207], v[108:111], v[28:31]
  v_mfma_f32_16x16x32_bf16 v[32:35], v[204:207], v[124:127], v[32:35]
  v_mfma_f32_16x16x32_bf16 v[36:39], v[204:207], v[140:143], v[36:39]
  v_mfma_f32_16x16x32_bf16 v[40:43], v[204:207], v[156:159], v[40:43]
  v_mfma_f32_16x16x32_bf16 v[44:47], v[204:207], v[172:175], v[44:47]
  s_lshl_b32 s41, s3, 12
  s_add_u32 s41, s41, 75776
  v_add_u32 v8, s41, v3
  s_xor_b32 s42, s3, 1
  s_lshl_b32 s42, s42, 12
  s_add_u32 s42, s42, 75776
  v_add_u32 v9, s42, v3
  v_lshlrev_b32 v10, 5, v5
  v_lshl_add_u32 v10, v6, 3, v10
  s_lshl_b32 s43, s51, 11
  s_sub_u32 s43, s52, s43
  s_add_u32 s43, s43, 35832
  v_sub_u32 v11, s43, v10
  v_and_b32 v13, 1, v6
  v_lshlrev_b32 v13, 4, v13
  v_add_u32 v13, v13, v5
  s_lshl_b32 s44, s51, 6
  v_add_u32 v13, s44, v13
  v_lshlrev_b32 v13, 6, v13
  v_lshrrev_b32 v14, 1, v6
  v_lshl_add_u32 v13, v14, 4, v13
  s_lshr_b32 s44, s3, 1
  s_lshl_b32 s44, s44, 5
  s_add_u32 s44, s44, 92160
  v_add_u32 v13, s44, v13
  s_lshl_b32 s44, s3, 11
  s_add_u32 s44, s44, 92160
  v_add_u32 v14, s44, v3
  v_lshrrev_b32 v10, 2, v2
  v_mul_u32_u24 v10, 14336, v10
  v_and_b32 v15, 3, v2
  v_lshl_add_u32 v10, v15, 4, v10
  s_and_b32 s44, s50, 0xfffffffe
  s_lshl_b32 s44, s44, 5
  s_mul_i32 s45, s3, 32*14336
  s_add_u32 s44, s44, s45
  v_add_u32 v10, s44, v10
  s_cmp_eq_u32 s51, 0
  s_cbranch_scc0 L_cp_34
  ds_write_b128 v8, v[32:35] offset:0
  ds_write_b128 v8, v[36:39] offset:1024
  ds_write_b128 v8, v[40:43] offset:2048
  ds_write_b128 v8, v[44:47] offset:3072
  s_branch L_cp_35
L_cp_34:
  s_nop 7
  ds_write_b128 v8, v[16:19] offset:0
  ds_write_b128 v8, v[20:23] offset:1024
  ds_write_b128 v8, v[24:27] offset:2048
  ds_write_b128 v8, v[28:31] offset:3072
  v_mov_b32 v16, v32
  v_mov_b32 v17, v33
  v_mov_b32 v18, v34
  v_mov_b32 v19, v35
  v_mov_b32 v20, v36
  v_mov_b32 v21, v37
  v_mov_b32 v22, v38
  v_mov_b32 v23, v39
  v_mov_b32 v24, v40
  v_mov_b32 v25, v41
  v_mov_b32 v26, v42
  v_mov_b32 v27, v43
  v_mov_b32 v28, v44
  v_mov_b32 v29, v45
  v_mov_b32 v30, v46
  v_mov_b32 v31, v47
L_cp_35:
  s_waitcnt lgkmcnt(0)
  s_lshl_b32 s36, s29, 16
  s_and_b32 s37, s29, 0xffff0000
  s_and_b32 s34, s50, 1
  s_cmp_eq_u32 s34, 0
  s_cselect_b32 s36, s36, s37
  s_waitcnt vmcnt(0)
  s_barrier
  s_cmp_lg_u32 s3, 0
  s_cbranch_scc1 L_gs_36
  v_lshlrev_b32 v250, 10, v2
  s_add_u32 s60, s90, 352
  s_lshl_b32 s60, s60, 7
  v_add_u32 v250, s60, v250
  v_mov_b32 v251, 1
  s_mov_b64 exec, 0xff
  buffer_atomic_add v251, v250, s[92:95], 0 offen sc1
  s_mov_b64 exec, -1
L_gs_36:
  ds_read_b128 v[48:51], v9 offset:0
  ds_read_b128 v[52:55], v9 offset:1024
  ds_read_b128 v[56:59], v9 offset:2048
  ds_read_b128 v[60:63], v9 offset:3072
  ds_read_b64 v[64:65], v11 offset:1536
  ds_read_b64 v[66:67], v11 offset:1024
  ds_read_b64 v[68:69], v11 offset:512
  ds_read_b64 v[70:71], v11 offset:0
  s_waitcnt lgkmcnt(0)
  v_add_f32 v16, v16, v48
  v_add_f32 v17, v17, v49
  v_add_f32 v18, v18, v50
  v_add_f32 v19, v19, v51
  v_and_b32 v72, 0xffff0000, v65
  v_lshlrev_b32 v73, 16, v65
  v_and_b32 v74, 0xffff0000, v64
  v_lshlrev_b32 v75, 16, v64
  v_fmac_f32 v16, s36, v72
  v_fmac_f32 v17, s36, v73
  v_fmac_f32 v18, s36, v74
  v_fmac_f32 v19, s36, v75
  v_cvt_pk_bf16_f32 v76, v16, v17
  v_cvt_pk_bf16_f32 v77, v18, v19
  v_add_f32 v20, v20, v52
  v_add_f32 v21, v21, v53
  v_add_f32 v22, v22, v54
  v_add_f32 v23, v23, v55
  v_and_b32 v72, 0xffff0000, v67
  v_lshlrev_b32 v73, 16, v67
  v_and_b32 v74, 0xffff0000, v66
  v_lshlrev_b32 v75, 16, v66
  v_fmac_f32 v20, s36, v72
  v_fmac_f32 v21, s36, v73
  v_fmac_f32 v22, s36, v74
  v_fmac_f32 v23, s36, v75
  v_cvt_pk_bf16_f32 v78, v20, v21
  v_cvt_pk_bf16_f32 v79, v22, v23
  v_add_f32 v24, v24, v56
  v_add_f32 v25, v25, v57
  v_add_f32 v26, v26, v58
  v_add_f32 v27, v27, v59
  v_and_b32 v72, 0xffff0000, v69
  v_lshlrev_b32 v73, 16, v69
  v_and_b32 v74, 0xffff0000, v68
  v_lshlrev_b32 v75, 16, v68
  v_fmac_f32 v24, s36, v72
  v_fmac_f32 v25, s36, v73
  v_fmac_f32 v26, s36, v74
  v_fmac_f32 v27, s36, v75
  v_cvt_pk_bf16_f32 v80, v24, v25
  v_cvt_pk_bf16_f32 v81, v26, v27
  v_add_f32 v28, v28, v60
  v_add_f32 v29, v29, v61
  v_add_f32 v30, v30, v62
  v_add_f32 v31, v31, v63
  v_and_b32 v72, 0xffff0000, v71
  v_lshlrev_b32 v73, 16, v71
  v_and_b32 v74, 0xffff0000, v70
  v_lshlrev_b32 v75, 16, v70
  v_fmac_f32 v28, s36, v72
  v_fmac_f32 v29, s36, v73
  v_fmac_f32 v30, s36, v74
  v_fmac_f32 v31, s36, v75
  v_cvt_pk_bf16_f32 v82, v28, v29
  v_cvt_pk_bf16_f32 v83, v30, v31
  v_permlane16_swap_b32 v76, v78
  v_permlane16_swap_b32 v77, v79
  ds_write_b128 v13, v[76:79] offset:0
  v_permlane16_swap_b32 v80, v82
  v_permlane16_swap_b32 v81, v83
  ds_write_b128 v13, v[80:83] offset:2048
  s_waitcnt lgkmcnt(0)
  s_barrier
  ds_read_b128 v[84:87], v14
  ds_read_b128 v[88:91], v14 offset:1024
  s_waitcnt lgkmcnt(1)
  buffer_store_dwordx4 v[84:87], v10, s[24:27], 0 offen sc1
  s_mov_b32 s45, 16*14336
  s_waitcnt lgkmcnt(0)
  buffer_store_dwordx4 v[88:91], v10, s[24:27], s45 offen sc1
  s_branch L_noconv_5
L_s0skip_6:
  v_lshrrev_b32 v62, 2, v2
  v_and_b32 v63, 3, v2
  v_lshlrev_b32 v63, 4, v63
  v_mul_u32_u24 v60, 3584, v62
  v_add_u32 v60, v60, v63
  v_mul_u32_u24 v61, 896, v62
  v_add_u32 v61, v61, v63
  s_mov_b32 s12, s48
  s_mul_i32 s13, s3, 5120
  s_add_u32 s13, s13, 100352
  s_mov_b32 m0, s13
  s_mul_hi_u32 s14, s12, 0x4924925
  s_mul_i32 s15, s14, 56
  s_sub_u32 s15, s12, s15
  s_lshr_b32 s28, s15, 1
  s_mul_i32 s28, s28, 16*3584
  s_lshl_b32 s29, s14, 6
  s_add_u32 s28, s28, s29
  s_and_b32 s15, s15, 1
  s_cmp_eq_u32 s15, 0
  s_cselect_b32 s16, s78, s80
  s_cselect_b32 s17, s79, s81
  s_mov_b32 s18, 0x188000
  s_mov_b32 s19, 0x20000
  buffer_load_dwordx4 v60, s[16:19], s28 offen lds
  s_lshl_b32 s40, s12, 10
  s_mov_b32 s34, 0
  s_add_u32 s12, s48, 1024
  s_mul_i32 s13, s3, 5120
  s_add_u32 s13, s13, 101376
  s_mov_b32 m0, s13
  s_mul_hi_u32 s14, s12, 0x4924925
  s_mul_i32 s15, s14, 56
  s_sub_u32 s15, s12, s15
  s_lshr_b32 s28, s15, 1
  s_mul_i32 s28, s28, 16*3584
  s_lshl_b32 s29, s14, 6
  s_add_u32 s28, s28, s29
  s_and_b32 s15, s15, 1
  s_cmp_eq_u32 s15, 0
  s_cselect_b32 s16, s78, s80
  s_cselect_b32 s17, s79, s81
  s_mov_b32 s18, 0x188000
  s_mov_b32 s19, 0x20000
  buffer_load_dwordx4 v60, s[16:19], s28 offen lds
  s_lshl_b32 s41, s12, 10
  s_mov_b32 s35, 0
  s_add_u32 s12, s48, 2048
  s_mul_i32 s13, s3, 5120
  s_add_u32 s13, s13, 102400
  s_mov_b32 m0, s13
  s_mul_hi_u32 s14, s12, 0x4924925
  s_mul_i32 s15, s14, 56
  s_sub_u32 s15, s12, s15
  s_lshr_b32 s28, s15, 1
  s_mul_i32 s28, s28, 16*3584
  s_lshl_b32 s29, s14, 6
  s_add_u32 s28, s28, s29
  s_and_b32 s15, s15, 1
  s_cmp_eq_u32 s15, 0
  s_cselect_b32 s16, s78, s80
  s_cselect_b32 s17, s79, s81
  s_mov_b32 s18, 0x188000
  s_mov_b32 s19, 0x20000
  buffer_load_dwordx4 v60, s[16:19], s28 offen lds
  s_lshl_b32 s42, s12, 10
  s_mov_b32 s36, 0
  s_mov_b32 s12, s48
  s_mul_i32 s13, s3, 5120
  s_add_u32 s13, s13, 103424
  s_mov_b32 m0, s13
  s_mul_hi_u32 s14, s12, 0x2492493
  s_mul_i32 s15, s14, 112
  s_sub_u32 s15, s12, s15
  s_mul_i32 s28, s15, 16*896
  s_lshl_b32 s29, s14, 6
  s_add_u32 s28, s28, s29
  s_mov_b32 s16, s82
  s_mov_b32 s17, s83
  s_mov_b32 s18, 0x188000
  s_mov_b32 s19, 0x20000
  buffer_load_dwordx4 v61, s[16:19], s28 offen lds
  s_lshl_b32 s43, s12, 10
  s_mov_b32 s37, 1
  s_mov_b32 s38, 2
  s_cmp_ge_u32 s48, 608
  s_cbranch_scc1 L_w4s_38
  s_cmp_ge_u32 s48, 544
  s_cbranch_scc1 L_w4g_37
  s_add_u32 s12, s48, 1024
  s_mul_i32 s13, s3, 5120
  s_add_u32 s13, s13, 104448
  s_mov_b32 m0, s13
  s_mul_hi_u32 s14, s12, 0x2492493
  s_mul_i32 s15, s14, 112
  s_sub_u32 s15, s12, s15
  s_mul_i32 s28, s15, 16*896
  s_lshl_b32 s29, s14, 6
  s_add_u32 s28, s28, s29
  s_mov_b32 s16, s82
  s_mov_b32 s17, s83
  s_mov_b32 s18, 0x188000
  s_mov_b32 s19, 0x20000
  buffer_load_dwordx4 v61, s[16:19], s28 offen lds
  s_lshl_b32 s44, s12, 10
  s_mov_b32 s38, 1
  s_branch L_w4d_39
L_w4g_37:
  s_add_u32 s12, s48, 3072-544
  s_mul_i32 s13, s3, 5120
  s_add_u32 s13, s13, 104448
  s_mov_b32 m0, s13
  s_mul_hi_u32 s14, s12, 0x4924925
  s_mul_i32 s15, s14, 56
  s_sub_u32 s15, s12, s15
  s_lshr_b32 s28, s15, 1
  s_mul_i32 s28, s28, 16*3584
  s_lshl_b32 s29, s14, 6
  s_add_u32 s28, s28, s29
  s_and_b32 s15, s15, 1
  s_cmp_eq_u32 s15, 0
  s_cselect_b32 s16, s78, s80
  s_cselect_b32 s17, s79, s81
  s_mov_b32 s18, 0x188000
  s_mov_b32 s19, 0x20000
  buffer_load_dwordx4 v60, s[16:19], s28 offen lds
  s_lshl_b32 s44, s12, 10
  s_mov_b32 s38, 0
  s_branch L_w4d_39
L_w4s_38:
  s_mul_i32 s13, s3, 5120
  s_add_u32 s13, s13, 104448
  s_mov_b32 m0, s13
  s_mov_b32 s16, s82
  s_mov_b32 s17, s83
  s_mov_b32 s18, 0x0
  s_mov_b32 s19, 0x20000
  buffer_load_dwordx4 v61, s[16:19], 0 offen lds
  s_mov_b32 s44, 0x7ff00000
L_w4d_39:
  s_waitcnt vmcnt(0)
  v_and_b32 v62, 15, v2
  v_lshrrev_b32 v63, 4, v2
  v_lshrrev_b32 v64, 2, v62
  v_and_b32 v65, 3, v62
  v_lshlrev_b32 v65, 3, v65
  v_and_b32 v66, 1, v63
  v_lshl_add_u32 v65, v66, 5, v65
  v_lshl_add_u32 v65, v64, 6, v65
  v_lshrrev_b32 v63, 1, v63
  s_mul_i32 s13, s3, 5120
  s_add_u32 s13, s13, 100352
  v_add_u32 v65, s13, v65
  v_lshl_add_u32 v66, v63, 9, v65
  v_lshl_add_u32 v67, v63, 8, v65
  ds_read_b64_tr_b16 v[112:113], v66 offset:0
  ds_read_b64_tr_b16 v[114:115], v66 offset:256
  ds_read_b64_tr_b16 v[116:117], v66 offset:1024
  ds_read_b64_tr_b16 v[118:119], v66 offset:1280
  ds_read_b64_tr_b16 v[120:121], v66 offset:2048
  ds_read_b64_tr_b16 v[122:123], v66 offset:2304
  ds_read_b64_tr_b16 v[124:125], v67 offset:3072
  ds_read_b64_tr_b16 v[126:127], v67 offset:3584
  s_cmp_eq_u32 s38, 1
  s_cbranch_scc1 L_trw_48
  ds_read_b64_tr_b16 v[128:129], v66 offset:4096
  ds_read_b64_tr_b16 v[130:131], v66 offset:4352
  s_branch L_tre_49
L_trw_48:
  ds_read_b64_tr_b16 v[128:129], v67 offset:4096
  ds_read_b64_tr_b16 v[130:131], v67 offset:4608
L_tre_49:
  s_waitcnt lgkmcnt(0)
  buffer_store_dwordx4 v[112:115], v3, s[4:7], s40 offen sc1
  buffer_store_dwordx4 v[116:119], v3, s[4:7], s41 offen sc1
  buffer_store_dwordx4 v[120:123], v3, s[4:7], s42 offen sc1
  buffer_store_dwordx4 v[124:127], v3, s[8:11], s43 offen sc1
  s_cmp_eq_u32 s38, 1
  s_cbranch_scc1 L_stw_50
  buffer_store_dwordx4 v[128:131], v3, s[4:7], s44 offen sc1
  s_branch L_ste_51
L_stw_50:
  buffer_store_dwordx4 v[128:131], v3, s[8:11], s44 offen sc1
L_ste_51:
  s_cmp_lg_u32 s3, 0
  s_cbranch_scc1 L_wi_52
  s_mov_b32 s56, s86
  s_mov_b32 s57, s87
  s_mov_b32 s58, 0x100
  s_mov_b32 s59, 0x20000
  v_mov_b32 v250, 0
  s_mov_b64 exec, 1
  s_mov_b32 s61, 0
L_wip_53:
  buffer_load_dword v251, v250, s[56:59], 0 offen sc1
  s_add_u32 s61, s61, 1
  s_waitcnt vmcnt(0)
  v_cmp_ne_u32 vcc, 0, v251
  s_cmp_ge_u32 s61, 400000
  s_cbranch_scc1 L_wid_54
  s_nop 0
  s_cmp_eq_u64 vcc, exec
  s_cbranch_scc0 L_wip_53
L_wid_54:
  s_mov_b64 exec, -1
L_wi_52:
  s_waitcnt vmcnt(0)
  s_barrier
  s_cmp_lg_u32 s3, 0
  s_cbranch_scc1 L_gs_55
  v_lshlrev_b32 v250, 10, v2
  s_add_u32 s60, s90, 352
  s_lshl_b32 s60, s60, 7
  v_add_u32 v250, s60, v250
  v_mov_b32 v251, 1
  s_mov_b64 exec, 0xff
  buffer_atomic_add v251, v250, s[92:95], 0 offen sc1
  s_mov_b64 exec, -1
L_gs_55:
  s_cmp_lg_u32 s3, 3
  s_cbranch_scc1 L_tk_56
  s_getreg_b32 s98, hwreg(HW_REG_XCC_ID, 0, 4)
  s_and_b32 s98, s98, 7
  s_add_u32 s12, s98, 24
  s_lshl_b32 s12, s12, 7
  v_mov_b32 v244, s12
  v_mov_b32 v245, 1
  s_mov_b64 exec, 1
  buffer_atomic_add v245, v244, s[92:95], 0 offen sc0 sc1
  s_mov_b64 exec, -1
L_tk_56:
L_noconv_5:
  s_waitcnt vmcnt(0)
  s_cmp_lg_u32 s3, 3
  s_cbranch_scc1 L_tr_57
  v_readfirstlane_b32 s12, v245
  s_nop 2
  s_cmp_lt_u32 s12, 32
  s_cbranch_scc1 L_trok_58
  v_lshlrev_b32 v244, 7, v2
  v_add_u32 v244, 3072, v244
  s_mov_b32 s15, 0
L_trp_59:
  s_mov_b64 exec, 0xff
  buffer_load_dword v243, v244, s[92:95], 0 offen sc1
  s_waitcnt vmcnt(0)
  s_mov_b64 exec, -1
  s_mov_b32 s13, 0
  v_readlane_b32 s14, v243, 0
  s_nop 2
  s_add_u32 s13, s13, s14
  v_readlane_b32 s14, v243, 1
  s_nop 2
  s_add_u32 s13, s13, s14
  v_readlane_b32 s14, v243, 2
  s_nop 2
  s_add_u32 s13, s13, s14
  v_readlane_b32 s14, v243, 3
  s_nop 2
  s_add_u32 s13, s13, s14
  v_readlane_b32 s14, v243, 4
  s_nop 2
  s_add_u32 s13, s13, s14
  v_readlane_b32 s14, v243, 5
  s_nop 2
  s_add_u32 s13, s13, s14
  v_readlane_b32 s14, v243, 6
  s_nop 2
  s_add_u32 s13, s13, s14
  v_readlane_b32 s14, v243, 7
  s_nop 2
  s_add_u32 s13, s13, s14
  s_add_u32 s15, s15, 1
  s_cmp_ge_u32 s15, 400000
  s_cbranch_scc1 L_trt_62
  s_cmp_lt_u32 s13, 256
  s_cbranch_scc1 L_trp_59
L_trt_62:
  v_mov_b32 v244, 896
  v_mov_b32 v245, 1
  s_mov_b64 exec, 1
  buffer_atomic_add v245, v244, s[92:95], 0 offen sc0 sc1
  s_waitcnt vmcnt(0)
  s_mov_b64 exec, -1
  v_readfirstlane_b32 s13, v245
  s_mov_b32 s98, 0
  s_mov_b32 s12, 31
  v_readlane_b32 s14, v243, 0
  s_nop 2
  s_min_u32 s14, s14, 32
  s_sub_u32 s15, 32, s14
  s_cmp_lt_u32 s13, s15
  s_cbranch_scc0 L_trx_63
  s_mov_b32 s98, 0
  s_add_u32 s12, s14, s13
  s_branch L_trok_58
L_trx_63:
  s_sub_u32 s13, s13, s15
  v_readlane_b32 s14, v243, 1
  s_nop 2
  s_min_u32 s14, s14, 32
  s_sub_u32 s15, 32, s14
  s_cmp_lt_u32 s13, s15
  s_cbranch_scc0 L_trx_64
  s_mov_b32 s98, 1
  s_add_u32 s12, s14, s13
  s_branch L_trok_58
L_trx_64:
  s_sub_u32 s13, s13, s15
  v_readlane_b32 s14, v243, 2
  s_nop 2
  s_min_u32 s14, s14, 32
  s_sub_u32 s15, 32, s14
  s_cmp_lt_u32 s13, s15
  s_cbranch_scc0 L_trx_65
  s_mov_b32 s98, 2
  s_add_u32 s12, s14, s13
  s_branch L_trok_58
L_trx_65:
  s_sub_u32 s13, s13, s15
  v_readlane_b32 s14, v243, 3
  s_nop 2
  s_min_u32 s14, s14, 32
  s_sub_u32 s15, 32, s14
  s_cmp_lt_u32 s13, s15
  s_cbranch_scc0 L_trx_66
  s_mov_b32 s98, 3
  s_add_u32 s12, s14, s13
  s_branch L_trok_58
L_trx_66:
  s_sub_u32 s13, s13, s15
  v_readlane_b32 s14, v243, 4
  s_nop 2
  s_min_u32 s14, s14, 32
  s_sub_u32 s15, 32, s14
  s_cmp_lt_u32 s13, s15
  s_cbranch_scc0 L_trx_67
  s_mov_b32 s98, 4
  s_add_u32 s12, s14, s13
  s_branch L_trok_58
L_trx_67:
  s_sub_u32 s13, s13, s15
  v_readlane_b32 s14, v243, 5
  s_nop 2
  s_min_u32 s14, s14, 32
  s_sub_u32 s15, 32, s14
  s_cmp_lt_u32 s13, s15
  s_cbranch_scc0 L_trx_68
  s_mov_b32 s98, 5
  s_add_u32 s12, s14, s13
  s_branch L_trok_58
L_trx_68:
  s_sub_u32 s13, s13, s15
  v_readlane_b32 s14, v243, 6
  s_nop 2
  s_min_u32 s14, s14, 32
  s_sub_u32 s15, 32, s14
  s_cmp_lt_u32 s13, s15
  s_cbranch_scc0 L_trx_69
  s_mov_b32 s98, 6
  s_add_u32 s12, s14, s13
  s_branch L_trok_58
L_trx_69:
  s_sub_u32 s13, s13, s15
  v_readlane_b32 s14, v243, 7
  s_nop 2
  s_min_u32 s14, s14, 32
  s_sub_u32 s15, 32, s14
  s_cmp_lt_u32 s13, s15
  s_cbranch_scc0 L_trx_70
  s_mov_b32 s98, 7
  s_add_u32 s12, s14, s13
  s_branch L_trok_58
L_trx_70:
  s_sub_u32 s13, s13, s15
L_trok_58:
  s_lshl_b32 s13, s98, 5
  s_add_u32 s13, s13, s12
  v_mov_b32 v244, s13
  v_mov_b32 v243, 163832
  ds_write_b32 v243, v244
L_tr_57:
  s_waitcnt lgkmcnt(0)
  s_barrier
  s_cmp_lg_u32 s3, 0
  s_cbranch_scc1 L_gs_71
  v_lshlrev_b32 v250, 10, v2
  s_add_u32 s60, s90, 416
  s_lshl_b32 s60, s60, 7
  v_add_u32 v250, s60, v250
  v_mov_b32 v251, 1
  s_mov_b64 exec, 0xff
  buffer_atomic_add v251, v250, s[92:95], 0 offen sc1
  s_mov_b64 exec, -1
L_gs_71:
  v_mov_b32 v243, 163832
  ds_read_b32 v244, v243
  s_waitcnt lgkmcnt(0)
  v_readfirstlane_b32 s12, v244
  s_nop 2
  s_lshr_b32 s98, s12, 5
  s_and_b32 s91, s12, 31
  s_mul_hi_u32 s15, s91, 0x24924925
  s_mul_i32 s28, s15, 7
  s_sub_u32 s49, s91, s28
  s_lshr_b32 s29, s98, 1
  s_lshl_b32 s29, s29, 2
  s_add_u32 s53, s29, s15
  s_and_b32 s30, s98, 1
  s_mul_i32 s30, s30, 7
  s_add_u32 s54, s30, s49
  s_lshl_b32 s29, s98, 2
  s_add_u32 s55, s29, s15
  s_lshl_b32 s31, s54, 2
  s_add_u32 s31, s31, s3
  s_mul_i32 s47, s31, 57344
  s_mul_i32 s46, s49, 224*1024
  s_mul_i32 s31, s3, 28*1024
  s_add_u32 s46, s46, s31
  v_and_b32 v33, 7, v2
  v_lshrrev_b32 v4, 3, v2
  s_mul_i32 s12, s3, 14
  v_add_u32 v5, s12, v4
  s_lshr_b32 s13, s2, 2
  s_mul_i32 s13, s13, 28672
  s_and_b32 s14, s2, 3
  s_lshl_b32 s14, s14, 7
  s_add_u32 s13, s13, s14
  v_lshlrev_b32 v6, 9, v5
  v_lshl_add_u32 v6, v33, 4, v6
  v_add_u32 v6, s13, v6
  v_add_u32 v7, 4096, v6
  v_mov_b32 v8, 0x80000000
  v_cmp_gt_u32 vcc, 6, v4
  v_cmp_gt_u32 s[38:39], 6, v4
  s_nop 0
  v_cndmask_b32 v7, v8, v7, vcc
  v_lshlrev_b32 v15, 3, v33
  v_add_u32 v15, 8064, v15
  s_lshl_b32 s37, s3, 6
  v_add_u32 v32, s37, v15
  v_lshlrev_b32 v11, 5, v0
  v_add_u32 v12, 8192, v11
  v_cmp_gt_u32 vcc, 192, v0
  s_nop 1
  v_cndmask_b32 v12, v8, v12, vcc
  v_lshrrev_b32 v13, 3, v0
  v_add_u32 v13, v13, v0
  v_lshlrev_b32 v13, 4, v13
  v_add_u32 v13, 0, v13
  v_mul_u32_u24 v14, 144, v5
  v_lshl_add_u32 v14, v33, 1, v14
  v_add_u32 v14, 0, v14
  v_lshlrev_b32 v36, 16, v232
  v_and_b32 v37, 0xffff0000, v232
  v_lshlrev_b32 v38, 16, v233
  v_and_b32 v39, 0xffff0000, v233
  v_lshlrev_b32 v40, 16, v234
  v_and_b32 v41, 0xffff0000, v234
  v_lshlrev_b32 v42, 16, v235
  v_and_b32 v43, 0xffff0000, v235
  v_lshlrev_b32 v44, 16, v236
  v_and_b32 v45, 0xffff0000, v236
  v_lshlrev_b32 v46, 16, v237
  v_and_b32 v47, 0xffff0000, v237
  v_lshlrev_b32 v48, 16, v238
  v_and_b32 v49, 0xffff0000, v238
  v_lshlrev_b32 v50, 16, v239
  v_and_b32 v51, 0xffff0000, v239
  v_add_f32 v84, v36, v37
  v_mul_f32 v85, v36, v36
  v_add_f32 v86, v38, v39
  v_mul_f32 v87, v37, v37
  v_fmac_f32 v85, v38, v38
  v_fmac_f32 v87, v39, v39
  v_add_f32 v84, v84, v40
  v_add_f32 v86, v86, v41
  v_fmac_f32 v85, v40, v40
  v_fmac_f32 v87, v41, v41
  v_add_f32 v84, v84, v42
  v_add_f32 v86, v86, v43
  v_fmac_f32 v85, v42, v42
  v_fmac_f32 v87, v43, v43
  v_add_f32 v84, v84, v44
  v_add_f32 v86, v86, v45
  v_fmac_f32 v85, v44, v44
  v_fmac_f32 v87, v45, v45
  v_add_f32 v84, v84, v46
  v_add_f32 v86, v86, v47
  v_fmac_f32 v85, v46, v46
  v_fmac_f32 v87, v47, v47
  v_add_f32 v84, v84, v48
  v_add_f32 v86, v86, v49
  v_fmac_f32 v85, v48, v48
  v_fmac_f32 v87, v49, v49
  v_add_f32 v84, v84, v50
  v_add_f32 v86, v86, v51
  v_fmac_f32 v85, v50, v50
  v_fmac_f32 v87, v51, v51
  v_add_f32 v84, v84, v86
  v_add_f32 v85, v85, v87
  s_nop 0
  v_add_f32_dpp v84, v84, v84 row_ror:8 row_mask:0xf bank_mask:0xf
  v_add_f32_dpp v85, v85, v85 row_ror:8 row_mask:0xf bank_mask:0xf
  v_mov_b32 v86, v84
  v_mov_b32 v87, v85
  s_nop 0
  v_permlane16_swap_b32 v84, v86
  v_permlane16_swap_b32 v85, v87
  v_add_f32 v84, v84, v86
  v_add_f32 v85, v85, v87
  v_mov_b32 v86, v84
  v_mov_b32 v87, v85
  s_nop 0
  v_permlane32_swap_b32 v84, v86
  v_permlane32_swap_b32 v85, v87
  v_add_f32 v84, v84, v86
  v_add_f32 v85, v85, v87
  v_cmp_gt_u32 vcc, 8, v2
  s_nop 2
  s_and_saveexec_b64 s[40:41], vcc
  ds_write_b64 v32, v[84:85] offset:0
  s_mov_b64 exec, s[40:41]
  s_waitcnt lgkmcnt(0)
  s_barrier
  ds_read_b64 v[88:89], v15 offset:0
  ds_read_b64 v[90:91], v15 offset:64
  ds_read_b64 v[92:93], v15 offset:128
  ds_read_b64 v[94:95], v15 offset:192
  s_waitcnt lgkmcnt(0)
  v_add_f32 v88, v88, v90
  v_add_f32 v89, v89, v91
  v_add_f32 v92, v92, v94
  v_add_f32 v93, v93, v95
  v_add_f32 v88, v88, v92
  v_add_f32 v89, v89, v93
  v_mul_f32 v84, 0x3b124925, v88
  v_mul_f32 v85, 0x3b124925, v89
  v_fma_f32 v85, -v84, v84, v85
  v_max_f32 v85, 0, v85
  v_add_f32 v85, 0x3727c5ac, v85
  v_rsq_f32 v85, v85
  s_nop 0
  v_mul_f32 v86, v84, v85
  v_fma_f32 v68, v36, v85, -v86
  v_fma_f32 v69, v37, v85, -v86
  v_fma_f32 v70, v38, v85, -v86
  v_fma_f32 v71, v39, v85, -v86
  v_fma_f32 v72, v40, v85, -v86
  v_fma_f32 v73, v41, v85, -v86
  v_fma_f32 v74, v42, v85, -v86
  v_fma_f32 v75, v43, v85, -v86
  v_fma_f32 v76, v44, v85, -v86
  v_fma_f32 v77, v45, v85, -v86
  v_fma_f32 v78, v46, v85, -v86
  v_fma_f32 v79, v47, v85, -v86
  v_fma_f32 v80, v48, v85, -v86
  v_fma_f32 v81, v49, v85, -v86
  v_fma_f32 v82, v50, v85, -v86
  v_fma_f32 v83, v51, v85, -v86
  s_lshl_b32 s59, s90, 3
  s_add_u32 s59, s59, 352
  s_cmp_lg_u32 s3, 0
  s_cbranch_scc1 L_wt_72
  v_lshlrev_b32 v250, 7, v2
  s_lshl_b32 s60, s59, 7
  v_add_u32 v250, s60, v250
  s_mov_b64 exec, 255
  s_mov_b32 s61, 0
L_pl_73:
  buffer_load_dword v251, v250, s[92:95], 0 offen sc1
  s_add_u32 s61, s61, 1
  s_waitcnt vmcnt(0)
  v_cmp_le_u32 vcc, 32, v251
  s_nop 2
  s_cmp_eq_u64 vcc, exec
  s_cbranch_scc1 L_pd_74
  s_sleep 6
  s_cmp_lt_u32 s61, 400000
  s_cbranch_scc1 L_pl_73
L_pd_74:
  s_mov_b64 exec, -1
L_wt_72:
  s_barrier
  s_add_u32 s45, s47, 0
  buffer_load_dwordx4 a[0:3], v3, s[4:7], s45 offen offset:0 sc1
  buffer_load_dwordx4 a[4:7], v3, s[4:7], s45 offen offset:1024 sc1
  buffer_load_dwordx4 a[8:11], v3, s[4:7], s45 offen offset:2048 sc1
  buffer_load_dwordx4 a[12:15], v3, s[4:7], s45 offen offset:3072 sc1
  s_add_u32 s45, s47, 4096
  buffer_load_dwordx4 a[16:19], v3, s[4:7], s45 offen offset:0 sc1
  buffer_load_dwordx4 a[20:23], v3, s[4:7], s45 offen offset:1024 sc1
  buffer_load_dwordx4 a[24:27], v3, s[4:7], s45 offen offset:2048 sc1
  buffer_load_dwordx4 a[28:31], v3, s[4:7], s45 offen offset:3072 sc1
  s_add_u32 s45, s47, 8192
  buffer_load_dwordx4 a[32:35], v3, s[4:7], s45 offen offset:0 sc1
  buffer_load_dwordx4 a[36:39], v3, s[4:7], s45 offen offset:1024 sc1
  buffer_load_dwordx4 a[40:43], v3, s[4:7], s45 offen offset:2048 sc1
  buffer_load_dwordx4 a[44:47], v3, s[4:7], s45 offen offset:3072 sc1
  s_add_u32 s45, s47, 12288
  buffer_load_dwordx4 a[48:51], v3, s[4:7], s45 offen offset:0 sc1
  buffer_load_dwordx4 a[52:55], v3, s[4:7], s45 offen offset:1024 sc1
  buffer_load_dwordx4 a[56:59], v3, s[4:7], s45 offen offset:2048 sc1
  buffer_load_dwordx4 a[60:63], v3, s[4:7], s45 offen offset:3072 sc1
  s_lshl_b32 s59, s90, 3
  s_add_u32 s59, s59, 416
  s_cmp_lg_u32 s3, 0
  s_cbranch_scc1 L_wt_75
  v_lshlrev_b32 v250, 7, v2
  s_lshl_b32 s60, s59, 7
  v_add_u32 v250, s60, v250
  s_mov_b64 exec, 255
  s_mov_b32 s61, 0
L_pl_76:
  buffer_load_dword v251, v250, s[92:95], 0 offen sc1
  s_add_u32 s61, s61, 1
  s_waitcnt vmcnt(0)
  v_cmp_le_u32 vcc, 32, v251
  s_nop 2
  s_cmp_eq_u64 vcc, exec
  s_cbranch_scc1 L_pd_77
  s_sleep 6
  s_cmp_lt_u32 s61, 400000
  s_cbranch_scc1 L_pl_76
L_pd_77:
  s_mov_b64 exec, -1
L_wt_75:
  s_barrier
  s_add_u32 s32, s88, 0x200000
  s_addc_u32 s33, s89, 0
  s_mov_b32 s34, 0x1c0000
  s_mov_b32 s35, 0x20000
  s_lshr_b32 s36, s2, 1
  s_mul_i32 s36, s36, 14336
  s_and_b32 s37, s2, 1
  s_lshl_b32 s37, s37, 4
  s_add_u32 s36, s36, s37
  buffer_load_dwordx4 v[24:27], v11, s[32:35], s36 offen sc1
  buffer_load_dwordx4 v[28:31], v12, s[32:35], s36 offen sc1
  s_add_u32 s16, s88, 0x800000
  s_addc_u32 s17, s89, 0
  s_mov_b32 s18, 0x1c0000
  s_mov_b32 s19, 0x20000
  s_add_u32 s20, s88, 0x600000
  s_addc_u32 s21, s89, 0
  s_mov_b32 s22, 0x1c0000
  s_mov_b32 s23, 0x20000
  s_add_u32 s24, s88, 0x400000
  s_addc_u32 s25, s89, 0
  s_mov_b32 s26, 0x1c0000
  s_mov_b32 s27, 0x20000
  s_add_u32 s45, s47, 16384
  buffer_load_dwordx4 a[64:67], v3, s[4:7], s45 offen offset:0 sc1
  buffer_load_dwordx4 a[68:71], v3, s[4:7], s45 offen offset:1024 sc1
  buffer_load_dwordx4 a[72:75], v3, s[4:7], s45 offen offset:2048 sc1
  buffer_load_dwordx4 a[76:79], v3, s[4:7], s45 offen offset:3072 sc1
  s_add_u32 s45, s47, 20480
  buffer_load_dwordx4 a[80:83], v3, s[4:7], s45 offen offset:0 sc1
  buffer_load_dwordx4 a[84:87], v3, s[4:7], s45 offen offset:1024 sc1
  s_waitcnt vmcnt(6)
  ds_write_b128 v13, v[24:27]
  v_cmp_gt_u32 vcc, 192, v0
  s_nop 2
  s_and_saveexec_b64 s[40:41], vcc
  ds_write_b128 v13, v[28:31] offset:4608
  s_mov_b64 exec, s[40:41]
  s_waitcnt lgkmcnt(0)
  s_barrier
  ds_read_u16 v52, v14 offset:0
  ds_read_u16 v53, v14 offset:16
  ds_read_u16 v54, v14 offset:32
  ds_read_u16 v55, v14 offset:48
  ds_read_u16 v56, v14 offset:64
  ds_read_u16 v57, v14 offset:80
  ds_read_u16 v58, v14 offset:96
  ds_read_u16 v59, v14 offset:112
  ds_read_u16 v60, v14 offset:1152
  ds_read_u16 v61, v14 offset:1168
  ds_read_u16 v62, v14 offset:1184
  ds_read_u16 v63, v14 offset:1200
  ds_read_u16 v64, v14 offset:1216
  ds_read_u16 v65, v14 offset:1232
  ds_read_u16 v66, v14 offset:1248
  ds_read_u16 v67, v14 offset:1264
  s_waitcnt lgkmcnt(0)
  v_lshl_or_b32 v24, v53, 16, v52
  v_lshl_or_b32 v25, v55, 16, v54
  v_lshl_or_b32 v26, v57, 16, v56
  v_lshl_or_b32 v27, v59, 16, v58
  v_lshl_or_b32 v28, v61, 16, v60
  v_lshl_or_b32 v29, v63, 16, v62
  v_lshl_or_b32 v30, v65, 16, v64
  v_lshl_or_b32 v31, v67, 16, v66
  v_lshlrev_b32 v52, 16, v52
  v_lshlrev_b32 v53, 16, v53
  v_lshlrev_b32 v54, 16, v54
  v_lshlrev_b32 v55, 16, v55
  v_lshlrev_b32 v56, 16, v56
  v_lshlrev_b32 v57, 16, v57
  v_lshlrev_b32 v58, 16, v58
  v_lshlrev_b32 v59, 16, v59
  v_lshlrev_b32 v60, 16, v60
  v_lshlrev_b32 v61, 16, v61
  v_lshlrev_b32 v62, 16, v62
  v_lshlrev_b32 v63, 16, v63
  v_lshlrev_b32 v64, 16, v64
  v_lshlrev_b32 v65, 16, v65
  v_lshlrev_b32 v66, 16, v66
  v_lshlrev_b32 v67, 16, v67
  v_cndmask_b32 v60, 0, v60, s[38:39]
  v_cndmask_b32 v61, 0, v61, s[38:39]
  v_cndmask_b32 v62, 0, v62, s[38:39]
  v_cndmask_b32 v63, 0, v63, s[38:39]
  v_cndmask_b32 v64, 0, v64, s[38:39]
  v_cndmask_b32 v65, 0, v65, s[38:39]
  v_cndmask_b32 v66, 0, v66, s[38:39]
  v_cndmask_b32 v67, 0, v67, s[38:39]
  buffer_store_dwordx4 v[24:27], v6, s[24:27], 0 offen sc1
  buffer_store_dwordx4 v[28:31], v7, s[24:27], 0 offen sc1
  v_fmac_f32 v36, v68, v52
  v_fmac_f32 v37, v69, v53
  v_fmac_f32 v38, v70, v54
  v_fmac_f32 v39, v71, v55
  v_fmac_f32 v40, v72, v56
  v_fmac_f32 v41, v73, v57
  v_fmac_f32 v42, v74, v58
  v_fmac_f32 v43, v75, v59
  v_fmac_f32 v44, v76, v60
  v_fmac_f32 v45, v77, v61
  v_fmac_f32 v46, v78, v62
  v_fmac_f32 v47, v79, v63
  v_fmac_f32 v48, v80, v64
  v_fmac_f32 v49, v81, v65
  v_fmac_f32 v50, v82, v66
  v_fmac_f32 v51, v83, v67
  v_cvt_pk_bf16_f32 v16, v36, v37
  v_cvt_pk_bf16_f32 v17, v38, v39
  v_cvt_pk_bf16_f32 v18, v40, v41
  v_cvt_pk_bf16_f32 v19, v42, v43
  v_cvt_pk_bf16_f32 v20, v44, v45
  v_cvt_pk_bf16_f32 v21, v46, v47
  v_cvt_pk_bf16_f32 v22, v48, v49
  v_cvt_pk_bf16_f32 v23, v50, v51
  v_lshlrev_b32 v36, 16, v16
  v_and_b32 v37, 0xffff0000, v16
  v_lshlrev_b32 v38, 16, v17
  v_and_b32 v39, 0xffff0000, v17
  v_lshlrev_b32 v40, 16, v18
  v_and_b32 v41, 0xffff0000, v18
  v_lshlrev_b32 v42, 16, v19
  v_and_b32 v43, 0xffff0000, v19
  v_lshlrev_b32 v44, 16, v20
  v_and_b32 v45, 0xffff0000, v20
  v_lshlrev_b32 v46, 16, v21
  v_and_b32 v47, 0xffff0000, v21
  v_lshlrev_b32 v48, 16, v22
  v_and_b32 v49, 0xffff0000, v22
  v_lshlrev_b32 v50, 16, v23
  v_and_b32 v51, 0xffff0000, v23
  buffer_store_dwordx4 v[16:19], v6, s[20:23], 0 offen sc1
  buffer_store_dwordx4 v[20:23], v7, s[20:23], 0 offen sc1
  v_add_f32 v84, v36, v37
  v_mul_f32 v85, v36, v36
  v_add_f32 v86, v38, v39
  v_mul_f32 v87, v37, v37
  v_fmac_f32 v85, v38, v38
  v_fmac_f32 v87, v39, v39
  v_add_f32 v84, v84, v40
  v_add_f32 v86, v86, v41
  v_fmac_f32 v85, v40, v40
  v_fmac_f32 v87, v41, v41
  v_add_f32 v84, v84, v42
  v_add_f32 v86, v86, v43
  v_fmac_f32 v85, v42, v42
  v_fmac_f32 v87, v43, v43
  v_add_f32 v84, v84, v44
  v_add_f32 v86, v86, v45
  v_fmac_f32 v85, v44, v44
  v_fmac_f32 v87, v45, v45
  v_add_f32 v84, v84, v46
  v_add_f32 v86, v86, v47
  v_fmac_f32 v85, v46, v46
  v_fmac_f32 v87, v47, v47
  v_add_f32 v84, v84, v48
  v_add_f32 v86, v86, v49
  v_fmac_f32 v85, v48, v48
  v_fmac_f32 v87, v49, v49
  v_add_f32 v84, v84, v50
  v_add_f32 v86, v86, v51
  v_fmac_f32 v85, v50, v50
  v_fmac_f32 v87, v51, v51
  v_add_f32 v84, v84, v86
  v_add_f32 v85, v85, v87
  s_nop 0
  v_add_f32_dpp v84, v84, v84 row_ror:8 row_mask:0xf bank_mask:0xf
  v_add_f32_dpp v85, v85, v85 row_ror:8 row_mask:0xf bank_mask:0xf
  v_mov_b32 v86, v84
  v_mov_b32 v87, v85
  s_nop 0
  v_permlane16_swap_b32 v84, v86
  v_permlane16_swap_b32 v85, v87
  v_add_f32 v84, v84, v86
  v_add_f32 v85, v85, v87
  v_mov_b32 v86, v84
  v_mov_b32 v87, v85
  s_nop 0
  v_permlane32_swap_b32 v84, v86
  v_permlane32_swap_b32 v85, v87
  v_add_f32 v84, v84, v86
  v_add_f32 v85, v85, v87
  v_cmp_gt_u32 vcc, 8, v2
  s_nop 2
  s_and_saveexec_b64 s[40:41], vcc
  ds_write_b64 v32, v[84:85] offset:256
  s_mov_b64 exec, s[40:41]
  s_waitcnt lgkmcnt(0)
  s_barrier
  ds_read_b64 v[88:89], v15 offset:256
  ds_read_b64 v[90:91], v15 offset:320
  ds_read_b64 v[92:93], v15 offset:384
  ds_read_b64 v[94:95], v15 offset:448
  s_waitcnt lgkmcnt(0)
  v_add_f32 v88, v88, v90
  v_add_f32 v89, v89, v91
  v_add_f32 v92, v92, v94
  v_add_f32 v93, v93, v95
  v_add_f32 v88, v88, v92
  v_add_f32 v89, v89, v93
  v_mul_f32 v84, 0x3b124925, v88
  v_mul_f32 v85, 0x3b124925, v89
  v_fma_f32 v85, -v84, v84, v85
  v_max_f32 v85, 0, v85
  v_add_f32 v85, 0x3727c5ac, v85
  v_rsq_f32 v85, v85
  s_nop 0
  v_mul_f32 v86, v84, v85
  v_fma_f32 v68, v36, v85, -v86
  v_fma_f32 v69, v37, v85, -v86
  v_fma_f32 v70, v38, v85, -v86
  v_fma_f32 v71, v39, v85, -v86
  v_fma_f32 v72, v40, v85, -v86
  v_fma_f32 v73, v41, v85, -v86
  v_fma_f32 v74, v42, v85, -v86
  v_fma_f32 v75, v43, v85, -v86
  v_fma_f32 v76, v44, v85, -v86
  v_fma_f32 v77, v45, v85, -v86
  v_fma_f32 v78, v46, v85, -v86
  v_fma_f32 v79, v47, v85, -v86
  v_fma_f32 v80, v48, v85, -v86
  v_fma_f32 v81, v49, v85, -v86
  v_fma_f32 v82, v50, v85, -v86
  v_fma_f32 v83, v51, v85, -v86
  v_cvt_pk_bf16_f32 v52, v68, v69
  v_cvt_pk_bf16_f32 v53, v70, v71
  v_cvt_pk_bf16_f32 v54, v72, v73
  v_cvt_pk_bf16_f32 v55, v74, v75
  v_cvt_pk_bf16_f32 v56, v76, v77
  v_cvt_pk_bf16_f32 v57, v78, v79
  v_cvt_pk_bf16_f32 v58, v80, v81
  v_cvt_pk_bf16_f32 v59, v82, v83
  buffer_store_dwordx4 v[52:55], v6, s[16:19], 0 offen sc1
  buffer_store_dwordx4 v[56:59], v7, s[16:19], 0 offen sc1
  s_add_u32 s45, s47, 20480
  buffer_load_dwordx4 a[88:91], v3, s[4:7], s45 offen offset:2048 sc1
  buffer_load_dwordx4 a[92:95], v3, s[4:7], s45 offen offset:3072 sc1
  s_add_u32 s45, s47, 24576
  buffer_load_dwordx4 a[96:99], v3, s[4:7], s45 offen offset:0 sc1
  buffer_load_dwordx4 a[100:103], v3, s[4:7], s45 offen offset:1024 sc1
  buffer_load_dwordx4 a[104:107], v3, s[4:7], s45 offen offset:2048 sc1
  buffer_load_dwordx4 a[108:111], v3, s[4:7], s45 offen offset:3072 sc1
  s_add_u32 s45, s47, 28672
  buffer_load_dwordx4 a[112:115], v3, s[4:7], s45 offen offset:0 sc1
  buffer_load_dwordx4 a[116:119], v3, s[4:7], s45 offen offset:1024 sc1
  buffer_load_dwordx4 a[120:123], v3, s[4:7], s45 offen offset:2048 sc1
  buffer_load_dwordx4 a[124:127], v3, s[4:7], s45 offen offset:3072 sc1
  s_lshr_b32 s59, s2, 2
  s_add_u32 s59, s59, 32
  s_waitcnt vmcnt(10)
  s_waitcnt lgkmcnt(0)
  s_barrier
  s_cmp_lg_u32 s3, 0
  s_cbranch_scc1 L_sig_78
  v_lshlrev_b32 v250, 7, v2
  s_lshl_b32 s60, s59, 7
  v_add_u32 v250, s60, v250
  v_mov_b32 v251, 1
  s_mov_b64 exec, 1
  buffer_atomic_add v251, v250, s[92:95], 0 offen sc1
  s_mov_b64 exec, -1
L_sig_78:
  s_cmp_ge_u32 s91, 28
  s_cbranch_scc1 L_gskip_80
  s_add_u32 s45, s47, 32768
  buffer_load_dwordx4 a[128:131], v3, s[4:7], s45 offen offset:0 sc1
  buffer_load_dwordx4 a[132:135], v3, s[4:7], s45 offen offset:1024 sc1
  buffer_load_dwordx4 a[136:139], v3, s[4:7], s45 offen offset:2048 sc1
  buffer_load_dwordx4 a[140:143], v3, s[4:7], s45 offen offset:3072 sc1
  s_add_u32 s45, s47, 36864
  buffer_load_dwordx4 a[144:147], v3, s[4:7], s45 offen offset:0 sc1
  buffer_load_dwordx4 a[148:151], v3, s[4:7], s45 offen offset:1024 sc1
  buffer_load_dwordx4 a[152:155], v3, s[4:7], s45 offen offset:2048 sc1
  buffer_load_dwordx4 a[156:159], v3, s[4:7], s45 offen offset:3072 sc1
  s_add_u32 s45, s47, 40960
  buffer_load_dwordx4 a[160:163], v3, s[4:7], s45 offen offset:0 sc1
  buffer_load_dwordx4 a[164:167], v3, s[4:7], s45 offen offset:1024 sc1
  buffer_load_dwordx4 a[168:171], v3, s[4:7], s45 offen offset:2048 sc1
  buffer_load_dwordx4 a[172:175], v3, s[4:7], s45 offen offset:3072 sc1
  s_add_u32 s45, s47, 45056
  buffer_load_dwordx4 a[176:179], v3, s[4:7], s45 offen offset:0 sc1
  buffer_load_dwordx4 a[180:183], v3, s[4:7], s45 offen offset:1024 sc1
  buffer_load_dwordx4 a[184:187], v3, s[4:7], s45 offen offset:2048 sc1
  buffer_load_dwordx4 a[188:191], v3, s[4:7], s45 offen offset:3072 sc1
  s_lshl_b32 s59, s53, 2
  s_add_u32 s59, s59, 32
  s_cmp_lg_u32 s3, 0
  s_cbranch_scc1 L_wt_81
  v_lshlrev_b32 v250, 7, v2
  s_lshl_b32 s60, s59, 7
  v_add_u32 v250, s60, v250
  s_mov_b64 exec, 3
  s_mov_b32 s61, 0
L_pl_82:
  buffer_load_dword v251, v250, s[92:95], 0 offen sc1
  s_add_u32 s61, s61, 1
  s_waitcnt vmcnt(0)
  v_cmp_le_u32 vcc, 4, v251
  s_nop 2
  s_cmp_eq_u64 vcc, exec
  s_cbranch_scc1 L_pd_83
  s_sleep 6
  s_cmp_lt_u32 s61, 400000
  s_cbranch_scc1 L_pl_82
L_pd_83:
  s_mov_b64 exec, -1
L_wt_81:
  s_barrier
  s_add_u32 s16, s88, 0x800000
  s_addc_u32 s17, s89, 0
  s_mov_b32 s18, 0x1c0000
  s_mov_b32 s19, 0x20000
  s_lshl_b32 s32, s53, 2
  s_mul_i32 s34, s32, 28672
  s_mul_i32 s36, s3, 7168
  s_add_u32 s34, s34, s36
  s_add_u32 s37, s34, 0
  buffer_load_dwordx4 v[112:115], v3, s[16:19], s37 offen offset:0 sc1
  buffer_load_dwordx4 v[116:119], v3, s[16:19], s37 offen offset:1024 sc1
  buffer_load_dwordx4 v[120:123], v3, s[16:19], s37 offen offset:2048 sc1
  buffer_load_dwordx4 v[124:127], v3, s[16:19], s37 offen offset:3072 sc1
  s_add_u32 s37, s34, 4096
  buffer_load_dwordx4 v[128:131], v3, s[16:19], s37 offen offset:0 sc1
  buffer_load_dwordx4 v[132:135], v3, s[16:19], s37 offen offset:1024 sc1
  buffer_load_dwordx4 v[136:139], v3, s[16:19], s37 offen offset:2048 sc1
  s_add_u32 s24, s88, 0x1600000
  s_addc_u32 s25, s89, 0
  s_mov_b32 s26, 0x700000
  s_mov_b32 s27, 0x20000
  v_add_u32 v4, s36, v3
  s_lshl_b32 s31, s54, 2
  s_add_u32 s31, s31, s3
  s_lshl_b32 s40, s31, 11
  s_add_u32 s21, s32, 34
  s_add_u32 s33, s32, 96
  s_lshr_b32 s12, s55, 1
  s_and_b32 s13, s55, 1
  s_lshl_b32 s14, s12, 2
  s_add_u32 s42, s14, s13
  s_sub_u32 s43, 3, s13
  s_add_u32 s43, s43, s14
  s_add_u32 s56, s42, 96
  s_add_u32 s57, s43, 96
  s_mul_i32 s12, s3, 28*1024
  s_mul_i32 s22, s42, 112*1024
  s_add_u32 s22, s22, s12
  s_mul_i32 s23, s43, 112*1024
  s_add_u32 s23, s23, s12
  s_mul_i32 s12, s3, 26624
  s_add_u32 s12, s12, 57344
  v_add_u32 v6, s12, v3
  s_add_u32 s28, s88, 0x141c000
  s_addc_u32 s29, s89, 0
  s_mov_b32 s30, 0x16c000
  s_mov_b32 s31, 0x20000
  s_waitcnt vmcnt(0)
  ds_write_b128 v4, v[112:115] offset:0
  ds_write_b128 v4, v[116:119] offset:1024
  ds_write_b128 v4, v[120:123] offset:2048
  ds_write_b128 v4, v[124:127] offset:3072
  ds_write_b128 v4, v[128:131] offset:4096
  ds_write_b128 v4, v[132:135] offset:5120
  ds_write_b128 v4, v[136:139] offset:6144
  s_waitcnt lgkmcnt(0)
  s_barrier
  ds_read_b128 v[80:83], v3 offset:0
  ds_read_b128 v[84:87], v3 offset:1024
  ds_read_b128 v[88:91], v3 offset:2048
  s_waitcnt lgkmcnt(2)
  v_mfma_f32_32x32x16_bf16 v[16:31], a[0:3], v[80:83], 0
  ds_read_b128 v[92:95], v3 offset:3072
  v_mfma_f32_32x32x16_bf16 v[32:47], a[4:7], v[80:83], 0
  s_add_u32 s37, s34, 28672
  buffer_load_dwordx4 v[140:143], v3, s[16:19], s37 offen offset:0 sc1
  s_waitcnt lgkmcnt(2)
  v_mfma_f32_32x32x16_bf16 v[16:31], a[8:11], v[84:87], v[16:31]
  ds_read_b128 v[80:83], v3 offset:4096
  v_mfma_f32_32x32x16_bf16 v[32:47], a[12:15], v[84:87], v[32:47]
  buffer_load_dwordx4 v[144:147], v3, s[16:19], s37 offen offset:1024 sc1
  s_waitcnt lgkmcnt(2)
  v_mfma_f32_32x32x16_bf16 v[16:31], a[16:19], v[88:91], v[16:31]
  ds_read_b128 v[84:87], v3 offset:5120
  v_mfma_f32_32x32x16_bf16 v[32:47], a[20:23], v[88:91], v[32:47]
  buffer_load_dwordx4 v[148:151], v3, s[16:19], s37 offen offset:2048 sc1
  s_waitcnt lgkmcnt(2)
  v_mfma_f32_32x32x16_bf16 v[16:31], a[24:27], v[92:95], v[16:31]
  ds_read_b128 v[88:91], v3 offset:6144
  v_mfma_f32_32x32x16_bf16 v[32:47], a[28:31], v[92:95], v[32:47]
  buffer_load_dwordx4 v[152:155], v3, s[16:19], s37 offen offset:3072 sc1
  s_waitcnt lgkmcnt(2)
  v_mfma_f32_32x32x16_bf16 v[16:31], a[32:35], v[80:83], v[16:31]
  ds_read_b128 v[92:95], v3 offset:7168
  v_mfma_f32_32x32x16_bf16 v[32:47], a[36:39], v[80:83], v[32:47]
  s_add_u32 s37, s34, 32768
  buffer_load_dwordx4 v[156:159], v3, s[16:19], s37 offen offset:0 sc1
  s_waitcnt lgkmcnt(2)
  v_mfma_f32_32x32x16_bf16 v[16:31], a[40:43], v[84:87], v[16:31]
  ds_read_b128 v[80:83], v3 offset:8192
  v_mfma_f32_32x32x16_bf16 v[32:47], a[44:47], v[84:87], v[32:47]
  buffer_load_dwordx4 v[160:163], v3, s[16:19], s37 offen offset:1024 sc1
  s_waitcnt lgkmcnt(2)
  v_mfma_f32_32x32x16_bf16 v[16:31], a[48:51], v[88:91], v[16:31]
  ds_read_b128 v[84:87], v3 offset:9216
  v_mfma_f32_32x32x16_bf16 v[32:47], a[52:55], v[88:91], v[32:47]
  buffer_load_dwordx4 v[164:167], v3, s[16:19], s37 offen offset:2048 sc1
  s_waitcnt lgkmcnt(2)
  v_mfma_f32_32x32x16_bf16 v[16:31], a[56:59], v[92:95], v[16:31]
  ds_read_b128 v[88:91], v3 offset:10240
  v_mfma_f32_32x32x16_bf16 v[32:47], a[60:63], v[92:95], v[32:47]
  s_add_u32 s45, s47, 49152
  buffer_load_dwordx4 a[192:195], v3, s[4:7], s45 offen offset:0 sc1
  s_waitcnt lgkmcnt(2)
  v_mfma_f32_32x32x16_bf16 v[16:31], a[64:67], v[80:83], v[16:31]
  ds_read_b128 v[92:95], v3 offset:11264
  v_mfma_f32_32x32x16_bf16 v[32:47], a[68:71], v[80:83], v[32:47]
  buffer_load_dwordx4 a[196:199], v3, s[4:7], s45 offen offset:1024 sc1
  s_waitcnt lgkmcnt(2)
  v_mfma_f32_32x32x16_bf16 v[16:31], a[72:75], v[84:87], v[16:31]
  ds_read_b128 v[80:83], v3 offset:12288
  v_mfma_f32_32x32x16_bf16 v[32:47], a[76:79], v[84:87], v[32:47]
  buffer_load_dwordx4 a[200:203], v3, s[4:7], s45 offen offset:2048 sc1
  s_waitcnt lgkmcnt(2)
  v_mfma_f32_32x32x16_bf16 v[16:31], a[80:83], v[88:91], v[16:31]
  ds_read_b128 v[84:87], v3 offset:13312
  v_mfma_f32_32x32x16_bf16 v[32:47], a[84:87], v[88:91], v[32:47]
  buffer_load_dwordx4 a[204:207], v3, s[4:7], s45 offen offset:3072 sc1
  s_waitcnt lgkmcnt(2)
  v_mfma_f32_32x32x16_bf16 v[16:31], a[88:91], v[92:95], v[16:31]
  ds_read_b128 v[88:91], v3 offset:14336
  v_mfma_f32_32x32x16_bf16 v[32:47], a[92:95], v[92:95], v[32:47]
  s_waitcnt vmcnt(4)
  ds_write_b128 v4, v[140:143] offset:28672
  s_add_u32 s45, s47, 53248
  buffer_load_dwordx4 a[208:211], v3, s[4:7], s45 offen offset:0 sc1
  s_waitcnt lgkmcnt(3)
  v_mfma_f32_32x32x16_bf16 v[16:31], a[96:99], v[80:83], v[16:31]
  ds_read_b128 v[92:95], v3 offset:15360
  v_mfma_f32_32x32x16_bf16 v[32:47], a[100:103], v[80:83], v[32:47]
  ds_write_b128 v4, v[144:147] offset:29696
  s_cmp_lg_u32 s3, 0
  s_cbranch_scc1 L_pi_84
  v_lshlrev_b32 v252, 7, v2
  s_lshl_b32 s60, s21, 7
  v_add_u32 v252, s60, v252
  s_mov_b64 exec, 3
  buffer_load_dword v253, v252, s[92:95], 0 offen sc1
  s_mov_b64 exec, -1
L_pi_84:
  buffer_load_dwordx4 a[212:215], v3, s[4:7], s45 offen offset:1024 sc1
  s_waitcnt lgkmcnt(4)
  v_mfma_f32_32x32x16_bf16 v[16:31], a[104:107], v[84:87], v[16:31]
  ds_read_b128 v[80:83], v3 offset:16384
  v_mfma_f32_32x32x16_bf16 v[32:47], a[108:111], v[84:87], v[32:47]
  ds_write_b128 v4, v[148:151] offset:30720
  buffer_load_dwordx4 a[216:219], v3, s[4:7], s45 offen offset:2048 sc1
  s_waitcnt lgkmcnt(5)
  v_mfma_f32_32x32x16_bf16 v[16:31], a[112:115], v[88:91], v[16:31]
  ds_read_b128 v[84:87], v3 offset:17408
  v_mfma_f32_32x32x16_bf16 v[32:47], a[116:119], v[88:91], v[32:47]
  ds_write_b128 v4, v[152:155] offset:31744
  buffer_load_dwordx4 a[220:223], v3, s[4:7], s45 offen offset:3072 sc1
  s_waitcnt lgkmcnt(5)
  v_mfma_f32_32x32x16_bf16 v[16:31], a[120:123], v[92:95], v[16:31]
  ds_read_b128 v[88:91], v3 offset:18432
  v_mfma_f32_32x32x16_bf16 v[32:47], a[124:127], v[92:95], v[32:47]
  ds_write_b128 v4, v[156:159] offset:32768
  s_waitcnt vmcnt(36)
  s_waitcnt lgkmcnt(5)
  v_mfma_f32_32x32x16_bf16 v[16:31], a[128:131], v[80:83], v[16:31]
  ds_read_b128 v[92:95], v3 offset:19456
  v_mfma_f32_32x32x16_bf16 v[32:47], a[132:135], v[80:83], v[32:47]
  ds_write_b128 v4, v[160:163] offset:33792
  s_waitcnt vmcnt(34)
  s_waitcnt lgkmcnt(5)
  v_mfma_f32_32x32x16_bf16 v[16:31], a[136:139], v[84:87], v[16:31]
  ds_read_b128 v[80:83], v3 offset:20480
  v_mfma_f32_32x32x16_bf16 v[32:47], a[140:143], v[84:87], v[32:47]
  ds_write_b128 v4, v[164:167] offset:34816
  s_add_u32 s20, s46, 0
  buffer_load_dwordx4 a[224:227], v3, s[8:11], s20 offen offset:0 sc1
  s_waitcnt vmcnt(33)
  s_waitcnt lgkmcnt(5)
  v_mfma_f32_32x32x16_bf16 v[16:31], a[144:147], v[88:91], v[16:31]
  ds_read_b128 v[84:87], v3 offset:21504
  v_mfma_f32_32x32x16_bf16 v[32:47], a[148:151], v[88:91], v[32:47]
  s_add_u32 s20, s46, 0
  buffer_load_dwordx4 a[228:231], v3, s[8:11], s20 offen offset:1024 sc1
  s_waitcnt vmcnt(32)
  s_waitcnt lgkmcnt(4)
  v_mfma_f32_32x32x16_bf16 v[16:31], a[152:155], v[92:95], v[16:31]
  ds_read_b128 v[88:91], v3 offset:22528
  v_mfma_f32_32x32x16_bf16 v[32:47], a[156:159], v[92:95], v[32:47]
  s_waitcnt lgkmcnt(2)
  s_barrier
  s_add_u32 s20, s46, 0
  buffer_load_dwordx4 a[232:235], v3, s[8:11], s20 offen offset:2048 sc1
  s_waitcnt vmcnt(31)
  v_mfma_f32_32x32x16_bf16 v[16:31], a[160:163], v[80:83], v[16:31]
  ds_read_b128 v[92:95], v3 offset:23552
  v_mfma_f32_32x32x16_bf16 v[32:47], a[164:167], v[80:83], v[32:47]
  s_cmp_lg_u32 s3, 0
  s_cbranch_scc1 L_pc_85
  s_waitcnt vmcnt(6)
  s_mov_b64 exec, 3
  v_cmp_le_u32 vcc, 4, v253
  s_nop 2
  s_cmp_eq_u64 vcc, exec
  s_mov_b64 exec, -1
  s_cbranch_scc1 L_pc_85
  s_cmp_lg_u32 s3, 0
  s_cbranch_scc1 L_wt_86
  v_lshlrev_b32 v250, 7, v2
  s_lshl_b32 s60, s21, 7
  v_add_u32 v250, s60, v250
  s_mov_b64 exec, 3
  s_mov_b32 s61, 0
L_pl_87:
  buffer_load_dword v251, v250, s[92:95], 0 offen sc1
  s_add_u32 s61, s61, 1
  s_waitcnt vmcnt(0)
  v_cmp_le_u32 vcc, 4, v251
  s_nop 2
  s_cmp_eq_u64 vcc, exec
  s_cbranch_scc1 L_pd_88
  s_sleep 6
  s_cmp_lt_u32 s61, 400000
  s_cbranch_scc1 L_pl_87
L_pd_88:
  s_mov_b64 exec, -1
L_wt_86:
L_pc_85:
  s_barrier
  s_add_u32 s20, s46, 0
  buffer_load_dwordx4 a[236:239], v3, s[8:11], s20 offen offset:3072 sc1
  s_waitcnt vmcnt(30)
  s_waitcnt lgkmcnt(2)
  v_mfma_f32_32x32x16_bf16 v[16:31], a[168:171], v[84:87], v[16:31]
  ds_read_b128 v[80:83], v3 offset:24576
  v_mfma_f32_32x32x16_bf16 v[32:47], a[172:175], v[84:87], v[32:47]
  s_add_u32 s37, s34, 57344
  buffer_load_dwordx4 v[112:115], v3, s[16:19], s37 offen offset:0 sc1
  s_waitcnt vmcnt(29)
  s_waitcnt lgkmcnt(2)
  v_mfma_f32_32x32x16_bf16 v[16:31], a[176:179], v[88:91], v[16:31]
  ds_read_b128 v[84:87], v3 offset:25600
  v_mfma_f32_32x32x16_bf16 v[32:47], a[180:183], v[88:91], v[32:47]
  buffer_load_dwordx4 v[116:119], v3, s[16:19], s37 offen offset:1024 sc1
  s_waitcnt vmcnt(28)
  s_waitcnt lgkmcnt(2)
  v_mfma_f32_32x32x16_bf16 v[16:31], a[184:187], v[92:95], v[16:31]
  ds_read_b128 v[88:91], v3 offset:26624
  v_mfma_f32_32x32x16_bf16 v[32:47], a[188:191], v[92:95], v[32:47]
  buffer_load_dwordx4 v[120:123], v3, s[16:19], s37 offen offset:2048 sc1
  s_waitcnt vmcnt(13)
  s_waitcnt lgkmcnt(2)
  v_mfma_f32_32x32x16_bf16 v[16:31], a[192:195], v[80:83], v[16:31]
  ds_read_b128 v[92:95], v3 offset:27648
  v_mfma_f32_32x32x16_bf16 v[32:47], a[196:199], v[80:83], v[32:47]
  buffer_load_dwordx4 v[124:127], v3, s[16:19], s37 offen offset:3072 sc1
  s_waitcnt vmcnt(12)
  s_waitcnt lgkmcnt(2)
  v_mfma_f32_32x32x16_bf16 v[16:31], a[200:203], v[84:87], v[16:31]
  ds_read_b128 v[80:83], v3 offset:28672
  v_mfma_f32_32x32x16_bf16 v[32:47], a[204:207], v[84:87], v[32:47]
  s_add_u32 s37, s34, 61440
  buffer_load_dwordx4 v[128:131], v3, s[16:19], s37 offen offset:0 sc1
  s_waitcnt vmcnt(11)
  s_waitcnt lgkmcnt(2)
  v_mfma_f32_32x32x16_bf16 v[16:31], a[208:211], v[88:91], v[16:31]
  ds_read_b128 v[84:87], v3 offset:29696
  v_mfma_f32_32x32x16_bf16 v[32:47], a[212:215], v[88:91], v[32:47]
  buffer_load_dwordx4 v[132:135], v3, s[16:19], s37 offen offset:1024 sc1
  s_waitcnt vmcnt(10)
  s_waitcnt lgkmcnt(2)
  v_mfma_f32_32x32x16_bf16 v[16:31], a[216:219], v[92:95], v[16:31]
  ds_read_b128 v[88:91], v3 offset:30720
  v_mfma_f32_32x32x16_bf16 v[32:47], a[220:223], v[92:95], v[32:47]
  buffer_load_dwordx4 v[136:139], v3, s[16:19], s37 offen offset:2048 sc1
  s_waitcnt lgkmcnt(2)
  v_mfma_f32_32x32x16_bf16 v[48:63], a[0:3], v[80:83], 0
  ds_read_b128 v[92:95], v3 offset:31744
  v_mfma_f32_32x32x16_bf16 v[64:79], a[4:7], v[80:83], 0
  s_add_u32 s37, s34, 86016
  buffer_load_dwordx4 v[140:143], v3, s[16:19], s37 offen offset:0 sc1
  s_waitcnt lgkmcnt(2)
  v_mfma_f32_32x32x16_bf16 v[48:63], a[8:11], v[84:87], v[48:63]
  ds_read_b128 v[80:83], v3 offset:32768
  s_add_u32 s41, s32, 0
  s_mul_i32 s41, s41, 112*1024
  s_add_u32 s41, s41, s40
  v_mul_f32 v96, 0xbfb8aa3b, v16
  v_mul_f32 v97, 0xbfb8aa3b, v17
  v_mfma_f32_32x32x16_bf16 v[64:79], a[12:15], v[84:87], v[64:79]
  v_mul_f32 v98, 0xbfb8aa3b, v18
  v_mul_f32 v99, 0xbfb8aa3b, v19
  buffer_load_dwordx4 v[144:147], v3, s[16:19], s37 offen offset:1024 sc1
  s_waitcnt lgkmcnt(2)
  v_mfma_f32_32x32x16_bf16 v[48:63], a[16:19], v[88:91], v[48:63]
  ds_read_b128 v[84:87], v3 offset:33792
  v_mul_f32 v100, 0xbfb8aa3b, v20
  v_mul_f32 v101, 0xbfb8aa3b, v21
  v_mfma_f32_32x32x16_bf16 v[64:79], a[20:23], v[88:91], v[64:79]
  v_mul_f32 v102, 0xbfb8aa3b, v22
  v_mul_f32 v103, 0xbfb8aa3b, v23
  buffer_load_dwordx4 v[148:151], v3, s[16:19], s37 offen offset:2048 sc1
  s_waitcnt lgkmcnt(2)
  v_mfma_f32_32x32x16_bf16 v[48:63], a[24:27], v[92:95], v[48:63]
  ds_read_b128 v[88:91], v3 offset:34816
  v_exp_f32 v96, v96
  v_exp_f32 v97, v97
  v_exp_f32 v98, v98
  v_mfma_f32_32x32x16_bf16 v[64:79], a[28:31], v[92:95], v[64:79]
  v_exp_f32 v99, v99
  v_exp_f32 v100, v100
  buffer_load_dwordx4 v[152:155], v3, s[16:19], s37 offen offset:3072 sc1
  s_waitcnt lgkmcnt(2)
  v_mfma_f32_32x32x16_bf16 v[48:63], a[32:35], v[80:83], v[48:63]
  ds_read_b128 v[92:95], v3 offset:35840
  v_exp_f32 v101, v101
  v_exp_f32 v102, v102
  v_mfma_f32_32x32x16_bf16 v[64:79], a[36:39], v[80:83], v[64:79]
  v_exp_f32 v103, v103
  v_mul_f32 v32, v16, v32
  s_add_u32 s37, s34, 90112
  buffer_load_dwordx4 v[156:159], v3, s[16:19], s37 offen offset:0 sc1
  s_waitcnt lgkmcnt(2)
  v_mfma_f32_32x32x16_bf16 v[48:63], a[40:43], v[84:87], v[48:63]
  ds_read_b128 v[80:83], v3 offset:36864
  v_mul_f32 v33, v17, v33
  v_mul_f32 v34, v18, v34
  v_mfma_f32_32x32x16_bf16 v[64:79], a[44:47], v[84:87], v[64:79]
  v_mul_f32 v35, v19, v35
  v_mul_f32 v36, v20, v36
  buffer_load_dwordx4 v[160:163], v3, s[16:19], s37 offen offset:1024 sc1
  s_waitcnt lgkmcnt(2)
  v_mfma_f32_32x32x16_bf16 v[48:63], a[48:51], v[88:91], v[48:63]
  ds_read_b128 v[84:87], v3 offset:37888
  v_mul_f32 v37, v21, v37
  v_mul_f32 v38, v22, v38
  v_mul_f32 v39, v23, v39
  v_mfma_f32_32x32x16_bf16 v[64:79], a[52:55], v[88:91], v[64:79]
  v_add_f32 v96, 1.0, v96
  v_add_f32 v97, 1.0, v97
  buffer_load_dwordx4 v[164:167], v3, s[16:19], s37 offen offset:2048 sc1
  s_waitcnt lgkmcnt(2)
  v_mfma_f32_32x32x16_bf16 v[48:63], a[56:59], v[92:95], v[48:63]
  ds_read_b128 v[88:91], v3 offset:38912
  v_add_f32 v98, 1.0, v98
  v_add_f32 v99, 1.0, v99
  v_mfma_f32_32x32x16_bf16 v[64:79], a[60:63], v[92:95], v[64:79]
  v_add_f32 v100, 1.0, v100
  v_add_f32 v101, 1.0, v101
  s_barrier
  s_add_u32 s20, s46, 4096
  buffer_load_dwordx4 a[240:243], v3, s[8:11], s20 offen offset:0 sc1
  s_waitcnt lgkmcnt(2)
  v_mfma_f32_32x32x16_bf16 v[48:63], a[64:67], v[80:83], v[48:63]
  ds_read_b128 v[92:95], v3 offset:39936
  v_add_f32 v102, 1.0, v102
  v_add_f32 v103, 1.0, v103
  v_mfma_f32_32x32x16_bf16 v[64:79], a[68:71], v[80:83], v[64:79]
  v_rcp_f32 v96, v96
  v_rcp_f32 v97, v97
  v_rcp_f32 v98, v98
  s_waitcnt vmcnt(8)
  ds_write_b128 v4, v[112:115] offset:0
  s_add_u32 s20, s46, 4096
  buffer_load_dwordx4 a[244:247], v3, s[8:11], s20 offen offset:1024 sc1
  s_waitcnt lgkmcnt(3)
  v_mfma_f32_32x32x16_bf16 v[48:63], a[72:75], v[84:87], v[48:63]
  ds_read_b128 v[80:83], v3 offset:40960
  v_rcp_f32 v99, v99
  v_rcp_f32 v100, v100
  v_mfma_f32_32x32x16_bf16 v[64:79], a[76:79], v[84:87], v[64:79]
  v_rcp_f32 v101, v101
  v_rcp_f32 v102, v102
  ds_write_b128 v4, v[116:119] offset:1024
  s_add_u32 s20, s46, 4096
  buffer_load_dwordx4 a[248:251], v3, s[8:11], s20 offen offset:2048 sc1
  s_waitcnt lgkmcnt(4)
  v_mfma_f32_32x32x16_bf16 v[48:63], a[80:83], v[88:91], v[48:63]
  ds_read_b128 v[84:87], v3 offset:41984
  v_rcp_f32 v103, v103
  v_mul_f32 v32, v32, v96
  v_mfma_f32_32x32x16_bf16 v[64:79], a[84:87], v[88:91], v[64:79]
  v_mul_f32 v33, v33, v97
  v_mul_f32 v34, v34, v98
  ds_write_b128 v4, v[120:123] offset:2048
  s_add_u32 s20, s46, 4096
  buffer_load_dwordx4 a[252:255], v3, s[8:11], s20 offen offset:3072 sc1
  s_waitcnt lgkmcnt(5)
  v_mfma_f32_32x32x16_bf16 v[48:63], a[88:91], v[92:95], v[48:63]
  ds_read_b128 v[88:91], v3 offset:43008
  v_mul_f32 v35, v35, v99
  v_mul_f32 v36, v36, v100
  v_mfma_f32_32x32x16_bf16 v[64:79], a[92:95], v[92:95], v[64:79]
  v_mul_f32 v37, v37, v101
  v_mul_f32 v38, v38, v102
  v_mul_f32 v39, v39, v103
  ds_write_b128 v4, v[124:127] offset:3072
  s_add_u32 s20, s46, 8192
  buffer_load_dwordx4 v[168:171], v3, s[8:11], s20 offen offset:0 sc1
  s_waitcnt lgkmcnt(5)
  v_mfma_f32_32x32x16_bf16 v[48:63], a[96:99], v[80:83], v[48:63]
  ds_read_b128 v[92:95], v3 offset:44032
  v_cvt_pk_bf16_f32 v16, v32, v33
  v_cvt_pk_bf16_f32 v17, v34, v35
  v_mfma_f32_32x32x16_bf16 v[64:79], a[100:103], v[80:83], v[64:79]
  v_cvt_pk_bf16_f32 v18, v36, v37
  v_cvt_pk_bf16_f32 v19, v38, v39
  ds_write_b128 v4, v[128:131] offset:4096
  s_add_u32 s20, s46, 8192
  buffer_load_dwordx4 v[172:175], v3, s[8:11], s20 offen offset:1024 sc1
  s_waitcnt lgkmcnt(5)
  v_mfma_f32_32x32x16_bf16 v[48:63], a[104:107], v[84:87], v[48:63]
  ds_read_b128 v[80:83], v3 offset:45056
  buffer_store_dwordx4 v[16:19], v3, s[24:27], s41 offen offset:0 sc1
  v_mul_f32 v96, 0xbfb8aa3b, v24
  v_mfma_f32_32x32x16_bf16 v[64:79], a[108:111], v[84:87], v[64:79]
  v_mul_f32 v97, 0xbfb8aa3b, v25
  v_mul_f32 v98, 0xbfb8aa3b, v26
  ds_write_b128 v4, v[132:135] offset:5120
  s_add_u32 s20, s46, 8192
  buffer_load_dwordx4 v[176:179], v3, s[8:11], s20 offen offset:2048 sc1
  s_waitcnt lgkmcnt(5)
  v_mfma_f32_32x32x16_bf16 v[48:63], a[112:115], v[88:91], v[48:63]
  ds_read_b128 v[84:87], v3 offset:46080
  v_mul_f32 v99, 0xbfb8aa3b, v27
  v_mul_f32 v100, 0xbfb8aa3b, v28
  v_mul_f32 v101, 0xbfb8aa3b, v29
  v_mfma_f32_32x32x16_bf16 v[64:79], a[116:119], v[88:91], v[64:79]
  v_mul_f32 v102, 0xbfb8aa3b, v30
  v_mul_f32 v103, 0xbfb8aa3b, v31
  ds_write_b128 v4, v[136:139] offset:6144
  s_add_u32 s20, s46, 8192
  buffer_load_dwordx4 v[180:183], v3, s[8:11], s20 offen offset:3072 sc1
  s_waitcnt lgkmcnt(5)
  v_mfma_f32_32x32x16_bf16 v[48:63], a[120:123], v[92:95], v[48:63]
  ds_read_b128 v[88:91], v3 offset:47104
  v_exp_f32 v96, v96
  v_exp_f32 v97, v97
  v_mfma_f32_32x32x16_bf16 v[64:79], a[124:127], v[92:95], v[64:79]
  v_exp_f32 v98, v98
  v_exp_f32 v99, v99
  s_add_u32 s20, s46, 12288
  buffer_load_dwordx4 v[184:187], v3, s[8:11], s20 offen offset:0 sc1
  s_waitcnt lgkmcnt(4)
  v_mfma_f32_32x32x16_bf16 v[48:63], a[128:131], v[80:83], v[48:63]
  ds_read_b128 v[92:95], v3 offset:48128
  v_exp_f32 v100, v100
  v_exp_f32 v101, v101
  v_mfma_f32_32x32x16_bf16 v[64:79], a[132:135], v[80:83], v[64:79]
  v_exp_f32 v102, v102
  v_exp_f32 v103, v103
  s_waitcnt lgkmcnt(2)
  s_barrier
  s_add_u32 s20, s46, 0
  buffer_load_dwordx4 v[112:115], v3, s[28:31], s20 offen offset:0 sc1
  v_mfma_f32_32x32x16_bf16 v[48:63], a[136:139], v[84:87], v[48:63]
  ds_read_b128 v[80:83], v3 offset:49152
  v_mul_f32 v40, v24, v40
  v_mul_f32 v41, v25, v41
  v_mul_f32 v42, v26, v42
  v_mfma_f32_32x32x16_bf16 v[64:79], a[140:143], v[84:87], v[64:79]
  v_mul_f32 v43, v27, v43
  v_mul_f32 v44, v28, v44
  s_add_u32 s20, s46, 0
  buffer_load_dwordx4 v[116:119], v3, s[28:31], s20 offen offset:1024 sc1
  s_waitcnt lgkmcnt(2)
  v_mfma_f32_32x32x16_bf16 v[48:63], a[144:147], v[88:91], v[48:63]
  ds_read_b128 v[84:87], v3 offset:50176
  v_mul_f32 v45, v29, v45
  v_mul_f32 v46, v30, v46
  v_mfma_f32_32x32x16_bf16 v[64:79], a[148:151], v[88:91], v[64:79]
  v_mul_f32 v47, v31, v47
  v_add_f32 v96, 1.0, v96
  s_add_u32 s20, s46, 0
  buffer_load_dwordx4 v[120:123], v3, s[28:31], s20 offen offset:2048 sc1
  s_waitcnt lgkmcnt(2)
  v_mfma_f32_32x32x16_bf16 v[48:63], a[152:155], v[92:95], v[48:63]
  ds_read_b128 v[88:91], v3 offset:51200
  v_add_f32 v97, 1.0, v97
  v_add_f32 v98, 1.0, v98
  v_mfma_f32_32x32x16_bf16 v[64:79], a[156:159], v[92:95], v[64:79]
  v_add_f32 v99, 1.0, v99
  v_add_f32 v100, 1.0, v100
  v_add_f32 v101, 1.0, v101
  s_add_u32 s20, s46, 0
  buffer_load_dwordx4 v[124:127], v3, s[28:31], s20 offen offset:3072 sc1
  s_waitcnt lgkmcnt(2)
  v_mfma_f32_32x32x16_bf16 v[48:63], a[160:163], v[80:83], v[48:63]
  ds_read_b128 v[92:95], v3 offset:52224
  v_add_f32 v102, 1.0, v102
  v_add_f32 v103, 1.0, v103
  v_mfma_f32_32x32x16_bf16 v[64:79], a[164:167], v[80:83], v[64:79]
  v_rcp_f32 v96, v96
  v_rcp_f32 v97, v97
  s_add_u32 s20, s46, 4096
  buffer_load_dwordx4 v[128:131], v3, s[28:31], s20 offen offset:0 sc1
  s_waitcnt lgkmcnt(2)
  v_mfma_f32_32x32x16_bf16 v[48:63], a[168:171], v[84:87], v[48:63]
  ds_read_b128 v[80:83], v3 offset:53248
  v_rcp_f32 v98, v98
  v_rcp_f32 v99, v99
  v_mfma_f32_32x32x16_bf16 v[64:79], a[172:175], v[84:87], v[64:79]
  v_rcp_f32 v100, v100
  v_rcp_f32 v101, v101
  s_add_u32 s20, s46, 4096
  buffer_load_dwordx4 v[132:135], v3, s[28:31], s20 offen offset:1024 sc1
  s_waitcnt lgkmcnt(2)
  v_mfma_f32_32x32x16_bf16 v[48:63], a[176:179], v[88:91], v[48:63]
  ds_read_b128 v[84:87], v3 offset:54272
  v_rcp_f32 v102, v102
  v_rcp_f32 v103, v103
  v_mfma_f32_32x32x16_bf16 v[64:79], a[180:183], v[88:91], v[64:79]
  v_mul_f32 v40, v40, v96
  v_mul_f32 v41, v41, v97
  v_mul_f32 v42, v42, v98
  s_add_u32 s20, s46, 4096
  buffer_load_dwordx4 v[136:139], v3, s[28:31], s20 offen offset:2048 sc1
  s_waitcnt lgkmcnt(2)
  v_mfma_f32_32x32x16_bf16 v[48:63], a[184:187], v[92:95], v[48:63]
  ds_read_b128 v[88:91], v3 offset:55296
  v_mul_f32 v43, v43, v99
  v_mul_f32 v44, v44, v100
  v_mfma_f32_32x32x16_bf16 v[64:79], a[188:191], v[92:95], v[64:79]
  v_mul_f32 v45, v45, v101
  v_mul_f32 v46, v46, v102
  s_add_u32 s20, s46, 12288
  buffer_load_dwordx4 v[188:191], v3, s[8:11], s20 offen offset:1024 sc1
  s_waitcnt lgkmcnt(2)
  v_mfma_f32_32x32x16_bf16 v[48:63], a[192:195], v[80:83], v[48:63]
  ds_read_b128 v[92:95], v3 offset:56320
  v_mul_f32 v47, v47, v103
  v_cvt_pk_bf16_f32 v24, v40, v41
  v_mfma_f32_32x32x16_bf16 v[64:79], a[196:199], v[80:83], v[64:79]
  v_cvt_pk_bf16_f32 v25, v42, v43
  v_cvt_pk_bf16_f32 v26, v44, v45
  s_add_u32 s20, s46, 12288
  buffer_load_dwordx4 v[192:195], v3, s[8:11], s20 offen offset:2048 sc1
  s_waitcnt lgkmcnt(2)
  v_mfma_f32_32x32x16_bf16 v[48:63], a[200:203], v[84:87], v[48:63]
  ds_read_b128 v[80:83], v3 offset:0
  v_cvt_pk_bf16_f32 v27, v46, v47
  buffer_store_dwordx4 v[24:27], v3, s[24:27], s41 offen offset:1024 sc1
  v_mfma_f32_32x32x16_bf16 v[64:79], a[204:207], v[84:87], v[64:79]
  s_add_u32 s20, s46, 12288
  buffer_load_dwordx4 v[196:199], v3, s[8:11], s20 offen offset:3072 sc1
  s_waitcnt lgkmcnt(2)
  v_mfma_f32_32x32x16_bf16 v[48:63], a[208:211], v[88:91], v[48:63]
  ds_read_b128 v[84:87], v3 offset:1024
  v_mfma_f32_32x32x16_bf16 v[64:79], a[212:215], v[88:91], v[64:79]
  s_add_u32 s20, s46, 16384
  buffer_load_dwordx4 v[200:203], v3, s[8:11], s20 offen offset:0 sc1
  s_waitcnt lgkmcnt(2)
  v_mfma_f32_32x32x16_bf16 v[48:63], a[216:219], v[92:95], v[48:63]
  ds_read_b128 v[88:91], v3 offset:2048
  v_mfma_f32_32x32x16_bf16 v[64:79], a[220:223], v[92:95], v[64:79]
  s_add_u32 s20, s46, 16384
  buffer_load_dwordx4 v[204:207], v3, s[8:11], s20 offen offset:1024 sc1
  s_waitcnt lgkmcnt(2)
  v_mfma_f32_32x32x16_bf16 v[16:31], a[0:3], v[80:83], 0
  ds_read_b128 v[92:95], v3 offset:3072
  v_mfma_f32_32x32x16_bf16 v[32:47], a[4:7], v[80:83], 0
  s_add_u32 s20, s46, 16384
  buffer_load_dwordx4 v[208:211], v3, s[8:11], s20 offen offset:2048 sc1
  s_waitcnt vmcnt(13)
  ds_write_b128 v6, v[112:115] offset:0
  s_waitcnt lgkmcnt(3)
  v_mfma_f32_32x32x16_bf16 v[16:31], a[8:11], v[84:87], v[16:31]
  ds_read_b128 v[80:83], v3 offset:4096
  s_add_u32 s41, s32, 1
  s_mul_i32 s41, s41, 112*1024
  s_add_u32 s41, s41, s40
  v_mul_f32 v96, 0xbfb8aa3b, v48
  v_mul_f32 v97, 0xbfb8aa3b, v49
  v_mfma_f32_32x32x16_bf16 v[32:47], a[12:15], v[84:87], v[32:47]
  v_mul_f32 v98, 0xbfb8aa3b, v50
  v_mul_f32 v99, 0xbfb8aa3b, v51
  s_add_u32 s20, s46, 16384
  buffer_load_dwordx4 v[212:215], v3, s[8:11], s20 offen offset:3072 sc1
  s_waitcnt vmcnt(13)
  ds_write_b128 v6, v[116:119] offset:1024
  s_waitcnt lgkmcnt(4)
  v_mfma_f32_32x32x16_bf16 v[16:31], a[16:19], v[88:91], v[16:31]
  ds_read_b128 v[84:87], v3 offset:5120
  v_mul_f32 v100, 0xbfb8aa3b, v52
  v_mul_f32 v101, 0xbfb8aa3b, v53
  v_mfma_f32_32x32x16_bf16 v[32:47], a[20:23], v[88:91], v[32:47]
  v_mul_f32 v102, 0xbfb8aa3b, v54
  v_mul_f32 v103, 0xbfb8aa3b, v55
  s_add_u32 s20, s46, 20480
  buffer_load_dwordx4 v[216:219], v3, s[8:11], s20 offen offset:0 sc1
  s_waitcnt vmcnt(13)
  ds_write_b128 v6, v[120:123] offset:2048
  s_waitcnt lgkmcnt(5)
  v_mfma_f32_32x32x16_bf16 v[16:31], a[24:27], v[92:95], v[16:31]
  ds_read_b128 v[88:91], v3 offset:6144
  v_exp_f32 v96, v96
  v_exp_f32 v97, v97
  v_exp_f32 v98, v98
  v_mfma_f32_32x32x16_bf16 v[32:47], a[28:31], v[92:95], v[32:47]
  v_exp_f32 v99, v99
  v_exp_f32 v100, v100
  s_add_u32 s20, s46, 20480
  buffer_load_dwordx4 v[220:223], v3, s[8:11], s20 offen offset:1024 sc1
  s_waitcnt vmcnt(13)
  ds_write_b128 v6, v[124:127] offset:3072
  s_waitcnt lgkmcnt(5)
  v_mfma_f32_32x32x16_bf16 v[16:31], a[32:35], v[80:83], v[16:31]
  ds_read_b128 v[92:95], v3 offset:7168
  v_exp_f32 v101, v101
  v_exp_f32 v102, v102
  v_mfma_f32_32x32x16_bf16 v[32:47], a[36:39], v[80:83], v[32:47]
  v_exp_f32 v103, v103
  v_mul_f32 v64, v48, v64
  s_add_u32 s20, s46, 20480
  buffer_load_dwordx4 v[224:227], v3, s[8:11], s20 offen offset:2048 sc1
  s_waitcnt vmcnt(13)
  ds_write_b128 v6, v[128:131] offset:4096
  s_waitcnt lgkmcnt(5)
  v_mfma_f32_32x32x16_bf16 v[16:31], a[40:43], v[84:87], v[16:31]
  ds_read_b128 v[80:83], v3 offset:8192
  v_mul_f32 v65, v49, v65
  v_mul_f32 v66, v50, v66
  v_mfma_f32_32x32x16_bf16 v[32:47], a[44:47], v[84:87], v[32:47]
  v_mul_f32 v67, v51, v67
  v_mul_f32 v68, v52, v68
  s_add_u32 s20, s46, 20480
  buffer_load_dwordx4 v[228:231], v3, s[8:11], s20 offen offset:3072 sc1
  s_waitcnt vmcnt(13)
  ds_write_b128 v6, v[132:135] offset:5120
  s_waitcnt lgkmcnt(5)
  v_mfma_f32_32x32x16_bf16 v[16:31], a[48:51], v[88:91], v[16:31]
  ds_read_b128 v[84:87], v3 offset:9216
  v_mul_f32 v69, v53, v69
  v_mul_f32 v70, v54, v70
  v_mul_f32 v71, v55, v71
  v_mfma_f32_32x32x16_bf16 v[32:47], a[52:55], v[88:91], v[32:47]
  v_add_f32 v96, 1.0, v96
  v_add_f32 v97, 1.0, v97
  s_add_u32 s20, s46, 24576
  buffer_load_dwordx4 v[232:235], v3, s[8:11], s20 offen offset:0 sc1
  s_waitcnt vmcnt(13)
  ds_write_b128 v6, v[136:139] offset:6144
  s_waitcnt lgkmcnt(5)
  v_mfma_f32_32x32x16_bf16 v[16:31], a[56:59], v[92:95], v[16:31]
  ds_read_b128 v[88:91], v3 offset:10240
  v_add_f32 v98, 1.0, v98
  v_add_f32 v99, 1.0, v99
  v_mfma_f32_32x32x16_bf16 v[32:47], a[60:63], v[92:95], v[32:47]
  v_add_f32 v100, 1.0, v100
  v_add_f32 v101, 1.0, v101
  s_barrier
  s_add_u32 s20, s46, 4096
  buffer_load_dwordx4 v[112:115], v3, s[28:31], s20 offen offset:3072 sc1
  s_waitcnt lgkmcnt(4)
  v_mfma_f32_32x32x16_bf16 v[16:31], a[64:67], v[80:83], v[16:31]
  ds_read_b128 v[92:95], v3 offset:11264
  v_add_f32 v102, 1.0, v102
  v_add_f32 v103, 1.0, v103
  v_mfma_f32_32x32x16_bf16 v[32:47], a[68:71], v[80:83], v[32:47]
  v_rcp_f32 v96, v96
  v_rcp_f32 v97, v97
  v_rcp_f32 v98, v98
  s_waitcnt vmcnt(31)
  ds_write_b128 v4, v[140:143] offset:28672
  s_add_u32 s20, s46, 8192
  buffer_load_dwordx4 v[116:119], v3, s[28:31], s20 offen offset:0 sc1
  s_waitcnt lgkmcnt(4)
  v_mfma_f32_32x32x16_bf16 v[16:31], a[72:75], v[84:87], v[16:31]
  ds_read_b128 v[80:83], v3 offset:12288
  v_rcp_f32 v99, v99
  v_rcp_f32 v100, v100
  v_mfma_f32_32x32x16_bf16 v[32:47], a[76:79], v[84:87], v[32:47]
  v_rcp_f32 v101, v101
  v_rcp_f32 v102, v102
  ds_write_b128 v4, v[144:147] offset:29696
  s_add_u32 s20, s46, 8192
  buffer_load_dwordx4 v[120:123], v3, s[28:31], s20 offen offset:1024 sc1
  s_waitcnt lgkmcnt(4)
  v_mfma_f32_32x32x16_bf16 v[16:31], a[80:83], v[88:91], v[16:31]
  ds_read_b128 v[84:87], v3 offset:13312
  v_rcp_f32 v103, v103
  v_mul_f32 v64, v64, v96
  v_mfma_f32_32x32x16_bf16 v[32:47], a[84:87], v[88:91], v[32:47]
  v_mul_f32 v65, v65, v97
  v_mul_f32 v66, v66, v98
  ds_write_b128 v4, v[148:151] offset:30720
  s_add_u32 s20, s46, 8192
  buffer_load_dwordx4 v[124:127], v3, s[28:31], s20 offen offset:2048 sc1
  s_waitcnt lgkmcnt(5)
  v_mfma_f32_32x32x16_bf16 v[16:31], a[88:91], v[92:95], v[16:31]
  ds_read_b128 v[88:91], v3 offset:14336
  v_mul_f32 v67, v67, v99
  v_mul_f32 v68, v68, v100
  v_mfma_f32_32x32x16_bf16 v[32:47], a[92:95], v[92:95], v[32:47]
  v_mul_f32 v69, v69, v101
  v_mul_f32 v70, v70, v102
  v_mul_f32 v71, v71, v103
  ds_write_b128 v4, v[152:155] offset:31744
  s_add_u32 s20, s46, 8192
  buffer_load_dwordx4 v[128:131], v3, s[28:31], s20 offen offset:3072 sc1
  s_waitcnt lgkmcnt(5)
  v_mfma_f32_32x32x16_bf16 v[16:31], a[96:99], v[80:83], v[16:31]
  ds_read_b128 v[92:95], v3 offset:15360
  v_cvt_pk_bf16_f32 v48, v64, v65
  v_cvt_pk_bf16_f32 v49, v66, v67
  v_mfma_f32_32x32x16_bf16 v[32:47], a[100:103], v[80:83], v[32:47]
  v_cvt_pk_bf16_f32 v50, v68, v69
  v_cvt_pk_bf16_f32 v51, v70, v71
  ds_write_b128 v4, v[156:159] offset:32768
  s_add_u32 s20, s46, 12288
  buffer_load_dwordx4 v[132:135], v3, s[28:31], s20 offen offset:0 sc1
  s_waitcnt lgkmcnt(5)
  v_mfma_f32_32x32x16_bf16 v[16:31], a[104:107], v[84:87], v[16:31]
  ds_read_b128 v[80:83], v3 offset:16384
  buffer_store_dwordx4 v[48:51], v3, s[24:27], s41 offen offset:0 sc1
  v_mul_f32 v96, 0xbfb8aa3b, v56
  v_mfma_f32_32x32x16_bf16 v[32:47], a[108:111], v[84:87], v[32:47]
  v_mul_f32 v97, 0xbfb8aa3b, v57
  v_mul_f32 v98, 0xbfb8aa3b, v58
  ds_write_b128 v4, v[160:163] offset:33792
  s_add_u32 s20, s46, 12288
  buffer_load_dwordx4 v[136:139], v3, s[28:31], s20 offen offset:1024 sc1
  s_waitcnt lgkmcnt(5)
  v_mfma_f32_32x32x16_bf16 v[16:31], a[112:115], v[88:91], v[16:31]
  ds_read_b128 v[84:87], v3 offset:17408
  v_mul_f32 v99, 0xbfb8aa3b, v59
  v_mul_f32 v100, 0xbfb8aa3b, v60
  v_mul_f32 v101, 0xbfb8aa3b, v61
  v_mfma_f32_32x32x16_bf16 v[32:47], a[116:119], v[88:91], v[32:47]
  v_mul_f32 v102, 0xbfb8aa3b, v62
  v_mul_f32 v103, 0xbfb8aa3b, v63
  ds_write_b128 v4, v[164:167] offset:34816
  s_add_u32 s20, s46, 24576
  buffer_load_dwordx4 v[236:239], v3, s[8:11], s20 offen offset:1024 sc1
  s_waitcnt lgkmcnt(5)
  v_mfma_f32_32x32x16_bf16 v[16:31], a[120:123], v[92:95], v[16:31]
  ds_read_b128 v[88:91], v3 offset:18432
  v_exp_f32 v96, v96
  v_exp_f32 v97, v97
  v_mfma_f32_32x32x16_bf16 v[32:47], a[124:127], v[92:95], v[32:47]
  v_exp_f32 v98, v98
  v_exp_f32 v99, v99
  s_add_u32 s20, s46, 24576
  buffer_load_dwordx4 v[240:243], v3, s[8:11], s20 offen offset:2048 sc1
  s_waitcnt lgkmcnt(4)
  v_mfma_f32_32x32x16_bf16 v[16:31], a[128:131], v[80:83], v[16:31]
  ds_read_b128 v[92:95], v3 offset:19456
  v_exp_f32 v100, v100
  v_exp_f32 v101, v101
  v_mfma_f32_32x32x16_bf16 v[32:47], a[132:135], v[80:83], v[32:47]
  v_exp_f32 v102, v102
  v_exp_f32 v103, v103
  s_waitcnt lgkmcnt(2)
  s_waitcnt vmcnt(20)
  s_barrier
  s_add_u32 s62, s33, 0
  s_cmp_lg_u32 s3, 0
  s_cbranch_scc1 L_sig_89
  v_lshlrev_b32 v250, 7, v2
  s_lshl_b32 s60, s62, 7
  v_add_u32 v250, s60, v250
  v_mov_b32 v251, 1
  s_mov_b64 exec, 1
  buffer_atomic_add v251, v250, s[92:95], 0 offen sc1
  s_mov_b64 exec, -1
L_sig_89:
  s_add_u32 s20, s46, 12288
  buffer_load_dwordx4 v[140:143], v3, s[28:31], s20 offen offset:2048 sc1
  v_mfma_f32_32x32x16_bf16 v[16:31], a[136:139], v[84:87], v[16:31]
  ds_read_b128 v[80:83], v3 offset:20480
  v_mul_f32 v72, v56, v72
  v_mul_f32 v73, v57, v73
  v_mul_f32 v74, v58, v74
  v_mfma_f32_32x32x16_bf16 v[32:47], a[140:143], v[84:87], v[32:47]
  v_mul_f32 v75, v59, v75
  v_mul_f32 v76, v60, v76
  s_add_u32 s20, s46, 12288
  buffer_load_dwordx4 v[144:147], v3, s[28:31], s20 offen offset:3072 sc1
  s_waitcnt lgkmcnt(2)
  v_mfma_f32_32x32x16_bf16 v[16:31], a[144:147], v[88:91], v[16:31]
  ds_read_b128 v[84:87], v3 offset:21504
  v_mul_f32 v77, v61, v77
  v_mul_f32 v78, v62, v78
  v_mfma_f32_32x32x16_bf16 v[32:47], a[148:151], v[88:91], v[32:47]
  v_mul_f32 v79, v63, v79
  v_add_f32 v96, 1.0, v96
  s_add_u32 s20, s46, 16384
  buffer_load_dwordx4 v[148:151], v3, s[28:31], s20 offen offset:0 sc1
  s_waitcnt lgkmcnt(2)
  v_mfma_f32_32x32x16_bf16 v[16:31], a[152:155], v[92:95], v[16:31]
  ds_read_b128 v[88:91], v3 offset:22528
  v_add_f32 v97, 1.0, v97
  v_add_f32 v98, 1.0, v98
  v_mfma_f32_32x32x16_bf16 v[32:47], a[156:159], v[92:95], v[32:47]
  v_add_f32 v99, 1.0, v99
  v_add_f32 v100, 1.0, v100
  v_add_f32 v101, 1.0, v101
  s_add_u32 s20, s46, 16384
  buffer_load_dwordx4 v[152:155], v3, s[28:31], s20 offen offset:1024 sc1
  s_waitcnt lgkmcnt(2)
  v_mfma_f32_32x32x16_bf16 v[16:31], a[160:163], v[80:83], v[16:31]
  ds_read_b128 v[92:95], v3 offset:23552
  v_add_f32 v102, 1.0, v102
  v_add_f32 v103, 1.0, v103
  v_mfma_f32_32x32x16_bf16 v[32:47], a[164:167], v[80:83], v[32:47]
  v_rcp_f32 v96, v96
  v_rcp_f32 v97, v97
  s_add_u32 s20, s46, 16384
  buffer_load_dwordx4 v[156:159], v3, s[28:31], s20 offen offset:2048 sc1
  s_waitcnt lgkmcnt(2)
  v_mfma_f32_32x32x16_bf16 v[16:31], a[168:171], v[84:87], v[16:31]
  ds_read_b128 v[80:83], v3 offset:24576
  v_rcp_f32 v98, v98
  v_rcp_f32 v99, v99
  v_mfma_f32_32x32x16_bf16 v[32:47], a[172:175], v[84:87], v[32:47]
  v_rcp_f32 v100, v100
  v_rcp_f32 v101, v101
  s_add_u32 s20, s46, 16384
  buffer_load_dwordx4 v[160:163], v3, s[28:31], s20 offen offset:3072 sc1
  s_waitcnt lgkmcnt(2)
  v_mfma_f32_32x32x16_bf16 v[16:31], a[176:179], v[88:91], v[16:31]
  ds_read_b128 v[84:87], v3 offset:25600
  v_rcp_f32 v102, v102
  v_rcp_f32 v103, v103
  v_mfma_f32_32x32x16_bf16 v[32:47], a[180:183], v[88:91], v[32:47]
  v_mul_f32 v72, v72, v96
  v_mul_f32 v73, v73, v97
  v_mul_f32 v74, v74, v98
  s_waitcnt vmcnt(15)
  ds_write_b128 v6, v[112:115] offset:7168
  s_add_u32 s20, s46, 20480
  buffer_load_dwordx4 v[164:167], v3, s[28:31], s20 offen offset:0 sc1
  s_waitcnt lgkmcnt(3)
  v_mfma_f32_32x32x16_bf16 v[16:31], a[184:187], v[92:95], v[16:31]
  ds_read_b128 v[88:91], v3 offset:26624
  v_mul_f32 v75, v75, v99
  v_mul_f32 v76, v76, v100
  v_mfma_f32_32x32x16_bf16 v[32:47], a[188:191], v[92:95], v[32:47]
  v_mul_f32 v77, v77, v101
  v_mul_f32 v78, v78, v102
  s_add_u32 s20, s46, 24576
  buffer_load_dwordx4 v[244:247], v3, s[8:11], s20 offen offset:3072 sc1
  s_waitcnt vmcnt(16)
  ds_write_b128 v6, v[116:119] offset:8192
  s_waitcnt lgkmcnt(4)
  v_mfma_f32_32x32x16_bf16 v[16:31], a[192:195], v[80:83], v[16:31]
  ds_read_b128 v[92:95], v3 offset:27648
  v_mul_f32 v79, v79, v103
  v_cvt_pk_bf16_f32 v56, v72, v73
  v_mfma_f32_32x32x16_bf16 v[32:47], a[196:199], v[80:83], v[32:47]
  v_cvt_pk_bf16_f32 v57, v74, v75
  v_cvt_pk_bf16_f32 v58, v76, v77
  s_add_u32 s20, s46, 24576
  buffer_load_dwordx4 v[104:107], v3, s[28:31], s20 offen offset:2048 sc1
  s_waitcnt vmcnt(16)
  ds_write_b128 v6, v[120:123] offset:9216
  s_waitcnt lgkmcnt(5)
  v_mfma_f32_32x32x16_bf16 v[16:31], a[200:203], v[84:87], v[16:31]
  ds_read_b128 v[80:83], v3 offset:28672
  v_cvt_pk_bf16_f32 v59, v78, v79
  buffer_store_dwordx4 v[56:59], v3, s[24:27], s41 offen offset:1024 sc1
  v_mfma_f32_32x32x16_bf16 v[32:47], a[204:207], v[84:87], v[32:47]
  s_add_u32 s20, s46, 24576
  buffer_load_dwordx4 v[108:111], v3, s[28:31], s20 offen offset:3072 sc1
  s_waitcnt vmcnt(17)
  ds_write_b128 v6, v[124:127] offset:10240
  s_waitcnt lgkmcnt(5)
  v_mfma_f32_32x32x16_bf16 v[16:31], a[208:211], v[88:91], v[16:31]
  ds_read_b128 v[84:87], v3 offset:29696
  v_mfma_f32_32x32x16_bf16 v[32:47], a[212:215], v[88:91], v[32:47]
  s_waitcnt vmcnt(16)
  ds_write_b128 v6, v[128:131] offset:11264
  s_waitcnt lgkmcnt(5)
  v_mfma_f32_32x32x16_bf16 v[16:31], a[216:219], v[92:95], v[16:31]
  ds_read_b128 v[88:91], v3 offset:30720
  v_mfma_f32_32x32x16_bf16 v[32:47], a[220:223], v[92:95], v[32:47]
  s_waitcnt vmcnt(15)
  ds_write_b128 v6, v[132:135] offset:12288
  s_waitcnt lgkmcnt(5)
  v_mfma_f32_32x32x16_bf16 v[48:63], a[0:3], v[80:83], 0
  ds_read_b128 v[92:95], v3 offset:31744
  v_mfma_f32_32x32x16_bf16 v[64:79], a[4:7], v[80:83], 0
  s_waitcnt vmcnt(13)
  ds_write_b128 v6, v[136:139] offset:13312
  s_waitcnt lgkmcnt(5)
  v_mfma_f32_32x32x16_bf16 v[48:63], a[8:11], v[84:87], v[48:63]
  ds_read_b128 v[80:83], v3 offset:32768
  s_add_u32 s41, s32, 2
  s_mul_i32 s41, s41, 112*1024
  s_add_u32 s41, s41, s40
  v_mul_f32 v96, 0xbfb8aa3b, v16
  v_mul_f32 v97, 0xbfb8aa3b, v17
  v_mfma_f32_32x32x16_bf16 v[64:79], a[12:15], v[84:87], v[64:79]
  v_mul_f32 v98, 0xbfb8aa3b, v18
  v_mul_f32 v99, 0xbfb8aa3b, v19
  s_add_u32 s20, s46, 20480
  buffer_load_dwordx4 v[112:115], v3, s[28:31], s20 offen offset:1024 sc1
  s_waitcnt lgkmcnt(4)
  v_mfma_f32_32x32x16_bf16 v[48:63], a[16:19], v[88:91], v[48:63]
  ds_read_b128 v[84:87], v3 offset:33792
  v_mul_f32 v100, 0xbfb8aa3b, v20
  v_mul_f32 v101, 0xbfb8aa3b, v21
  v_mfma_f32_32x32x16_bf16 v[64:79], a[20:23], v[88:91], v[64:79]
  v_mul_f32 v102, 0xbfb8aa3b, v22
  v_mul_f32 v103, 0xbfb8aa3b, v23
  s_waitcnt vmcnt(11)
  ds_write_b128 v6, v[140:143] offset:14336
  s_add_u32 s20, s46, 20480
  buffer_load_dwordx4 v[116:119], v3, s[28:31], s20 offen offset:2048 sc1
  s_waitcnt lgkmcnt(4)
  v_mfma_f32_32x32x16_bf16 v[48:63], a[24:27], v[92:95], v[48:63]
  ds_read_b128 v[88:91], v3 offset:34816
  v_exp_f32 v96, v96
  v_exp_f32 v97, v97
  v_exp_f32 v98, v98
  v_mfma_f32_32x32x16_bf16 v[64:79], a[28:31], v[92:95], v[64:79]
  v_exp_f32 v99, v99
  v_exp_f32 v100, v100
  s_waitcnt vmcnt(11)
  ds_write_b128 v6, v[144:147] offset:15360
  s_add_u32 s20, s46, 20480
  buffer_load_dwordx4 v[120:123], v3, s[28:31], s20 offen offset:3072 sc1
  s_waitcnt lgkmcnt(4)
  v_mfma_f32_32x32x16_bf16 v[48:63], a[32:35], v[80:83], v[48:63]
  ds_read_b128 v[92:95], v3 offset:35840
  v_exp_f32 v101, v101
  v_exp_f32 v102, v102
  v_mfma_f32_32x32x16_bf16 v[64:79], a[36:39], v[80:83], v[64:79]
  v_exp_f32 v103, v103
  v_mul_f32 v32, v16, v32
  s_waitcnt vmcnt(11)
  ds_write_b128 v6, v[148:151] offset:16384
  s_add_u32 s20, s46, 24576
  buffer_load_dwordx4 v[124:127], v3, s[28:31], s20 offen offset:0 sc1
  s_waitcnt lgkmcnt(5)
  v_mfma_f32_32x32x16_bf16 v[48:63], a[40:43], v[84:87], v[48:63]
  ds_read_b128 v[80:83], v3 offset:36864
  v_mul_f32 v33, v17, v33
  v_mul_f32 v34, v18, v34
  v_mfma_f32_32x32x16_bf16 v[64:79], a[44:47], v[84:87], v[64:79]
  v_mul_f32 v35, v19, v35
  v_mul_f32 v36, v20, v36
  s_waitcnt vmcnt(11)
  ds_write_b128 v6, v[152:155] offset:17408
  s_add_u32 s20, s46, 24576
  buffer_load_dwordx4 v[128:131], v3, s[28:31], s20 offen offset:1024 sc1
  s_waitcnt lgkmcnt(5)
  v_mfma_f32_32x32x16_bf16 v[48:63], a[48:51], v[88:91], v[48:63]
  ds_read_b128 v[84:87], v3 offset:37888
  v_mul_f32 v37, v21, v37
  v_mul_f32 v38, v22, v38
  v_mul_f32 v39, v23, v39
  v_mfma_f32_32x32x16_bf16 v[64:79], a[52:55], v[88:91], v[64:79]
  v_add_f32 v96, 1.0, v96
  v_add_f32 v97, 1.0, v97
  s_waitcnt vmcnt(11)
  ds_write_b128 v6, v[156:159] offset:18432
  s_waitcnt lgkmcnt(5)
  v_mfma_f32_32x32x16_bf16 v[48:63], a[56:59], v[92:95], v[48:63]
  ds_read_b128 v[88:91], v3 offset:38912
  v_add_f32 v98, 1.0, v98
  v_add_f32 v99, 1.0, v99
  v_mfma_f32_32x32x16_bf16 v[64:79], a[60:63], v[92:95], v[64:79]
  v_add_f32 v100, 1.0, v100
  v_add_f32 v101, 1.0, v101
  s_waitcnt vmcnt(10)
  ds_write_b128 v6, v[160:163] offset:19456
  s_waitcnt lgkmcnt(5)
  v_mfma_f32_32x32x16_bf16 v[48:63], a[64:67], v[80:83], v[48:63]
  ds_read_b128 v[92:95], v3 offset:39936
  v_add_f32 v102, 1.0, v102
  v_add_f32 v103, 1.0, v103
  v_mfma_f32_32x32x16_bf16 v[64:79], a[68:71], v[80:83], v[64:79]
  v_rcp_f32 v96, v96
  v_rcp_f32 v97, v97
  v_rcp_f32 v98, v98
  s_waitcnt vmcnt(9)
  ds_write_b128 v6, v[164:167] offset:20480
  s_waitcnt lgkmcnt(5)
  v_mfma_f32_32x32x16_bf16 v[48:63], a[72:75], v[84:87], v[48:63]
  ds_read_b128 v[80:83], v3 offset:40960
  v_rcp_f32 v99, v99
  v_rcp_f32 v100, v100
  v_mfma_f32_32x32x16_bf16 v[64:79], a[76:79], v[84:87], v[64:79]
  v_rcp_f32 v101, v101
  v_rcp_f32 v102, v102
  s_waitcnt lgkmcnt(4)
  v_mfma_f32_32x32x16_bf16 v[48:63], a[80:83], v[88:91], v[48:63]
  ds_read_b128 v[84:87], v3 offset:41984
  v_rcp_f32 v103, v103
  v_mul_f32 v32, v32, v96
  v_mfma_f32_32x32x16_bf16 v[64:79], a[84:87], v[88:91], v[64:79]
  v_mul_f32 v33, v33, v97
  v_mul_f32 v34, v34, v98
  s_waitcnt lgkmcnt(3)
  v_mfma_f32_32x32x16_bf16 v[48:63], a[88:91], v[92:95], v[48:63]
  ds_read_b128 v[88:91], v3 offset:43008
  v_mul_f32 v35, v35, v99
  v_mul_f32 v36, v36, v100
  v_mfma_f32_32x32x16_bf16 v[64:79], a[92:95], v[92:95], v[64:79]
  v_mul_f32 v37, v37, v101
  v_mul_f32 v38, v38, v102
  v_mul_f32 v39, v39, v103
  s_waitcnt lgkmcnt(2)
  v_mfma_f32_32x32x16_bf16 v[48:63], a[96:99], v[80:83], v[48:63]
  ds_read_b128 v[92:95], v3 offset:44032
  v_cvt_pk_bf16_f32 v16, v32, v33
  v_cvt_pk_bf16_f32 v17, v34, v35
  v_mfma_f32_32x32x16_bf16 v[64:79], a[100:103], v[80:83], v[64:79]
  v_cvt_pk_bf16_f32 v18, v36, v37
  v_cvt_pk_bf16_f32 v19, v38, v39
  s_waitcnt lgkmcnt(2)
  v_mfma_f32_32x32x16_bf16 v[48:63], a[104:107], v[84:87], v[48:63]
  ds_read_b128 v[80:83], v3 offset:45056
  buffer_store_dwordx4 v[16:19], v3, s[24:27], s41 offen offset:0 sc1
  v_mul_f32 v96, 0xbfb8aa3b, v24
  v_mfma_f32_32x32x16_bf16 v[64:79], a[108:111], v[84:87], v[64:79]
  v_mul_f32 v97, 0xbfb8aa3b, v25
  v_mul_f32 v98, 0xbfb8aa3b, v26
  s_waitcnt lgkmcnt(2)
  v_mfma_f32_32x32x16_bf16 v[48:63], a[112:115], v[88:91], v[48:63]
  ds_read_b128 v[84:87], v3 offset:46080
  v_mul_f32 v99, 0xbfb8aa3b, v27
  v_mul_f32 v100, 0xbfb8aa3b, v28
  v_mul_f32 v101, 0xbfb8aa3b, v29
  v_mfma_f32_32x32x16_bf16 v[64:79], a[116:119], v[88:91], v[64:79]
  v_mul_f32 v102, 0xbfb8aa3b, v30
  v_mul_f32 v103, 0xbfb8aa3b, v31
  s_waitcnt vmcnt(5)
  ds_write_b128 v6, v[112:115] offset:21504
  s_waitcnt lgkmcnt(3)
  v_mfma_f32_32x32x16_bf16 v[48:63], a[120:123], v[92:95], v[48:63]
  ds_read_b128 v[88:91], v3 offset:47104
  v_exp_f32 v96, v96
  v_exp_f32 v97, v97
  v_mfma_f32_32x32x16_bf16 v[64:79], a[124:127], v[92:95], v[64:79]
  v_exp_f32 v98, v98
  v_exp_f32 v99, v99
  s_waitcnt vmcnt(4)
  ds_write_b128 v6, v[116:119] offset:22528
  s_waitcnt lgkmcnt(4)
  v_mfma_f32_32x32x16_bf16 v[48:63], a[128:131], v[80:83], v[48:63]
  ds_read_b128 v[92:95], v3 offset:48128
  v_exp_f32 v100, v100
  v_exp_f32 v101, v101
  v_mfma_f32_32x32x16_bf16 v[64:79], a[132:135], v[80:83], v[64:79]
  v_exp_f32 v102, v102
  v_exp_f32 v103, v103
  s_waitcnt vmcnt(7)
  s_barrier
  s_add_u32 s62, s33, 1
  s_cmp_lg_u32 s3, 0
  s_cbranch_scc1 L_sig_90
  v_lshlrev_b32 v250, 7, v2
  s_lshl_b32 s60, s62, 7
  v_add_u32 v250, s60, v250
  v_mov_b32 v251, 1
  s_mov_b64 exec, 1
  buffer_atomic_add v251, v250, s[92:95], 0 offen sc1
  s_mov_b64 exec, -1
L_sig_90:
  s_waitcnt vmcnt(3)
  ds_write_b128 v6, v[120:123] offset:23552
  s_waitcnt lgkmcnt(5)
  v_mfma_f32_32x32x16_bf16 v[48:63], a[136:139], v[84:87], v[48:63]
  ds_read_b128 v[80:83], v3 offset:49152
  v_mul_f32 v40, v24, v40
  v_mul_f32 v41, v25, v41
  v_mul_f32 v42, v26, v42
  v_mfma_f32_32x32x16_bf16 v[64:79], a[140:143], v[84:87], v[64:79]
  v_mul_f32 v43, v27, v43
  v_mul_f32 v44, v28, v44
  s_waitcnt vmcnt(2)
  ds_write_b128 v6, v[124:127] offset:24576
  s_waitcnt lgkmcnt(5)
  v_mfma_f32_32x32x16_bf16 v[48:63], a[144:147], v[88:91], v[48:63]
  ds_read_b128 v[84:87], v3 offset:50176
  v_mul_f32 v45, v29, v45
  v_mul_f32 v46, v30, v46
  v_mfma_f32_32x32x16_bf16 v[64:79], a[148:151], v[88:91], v[64:79]
  v_mul_f32 v47, v31, v47
  v_add_f32 v96, 1.0, v96
  s_waitcnt vmcnt(1)
  ds_write_b128 v6, v[128:131] offset:25600
  s_waitcnt lgkmcnt(5)
  v_mfma_f32_32x32x16_bf16 v[48:63], a[152:155], v[92:95], v[48:63]
  ds_read_b128 v[88:91], v3 offset:51200
  v_add_f32 v97, 1.0, v97
  v_add_f32 v98, 1.0, v98
  v_mfma_f32_32x32x16_bf16 v[64:79], a[156:159], v[92:95], v[64:79]
  v_add_f32 v99, 1.0, v99
  v_add_f32 v100, 1.0, v100
  v_add_f32 v101, 1.0, v101
  s_cmp_lg_u32 s3, 0
  s_cbranch_scc1 L_pi_91
  v_lshlrev_b32 v252, 7, v2
  s_lshl_b32 s60, s56, 7
  v_add_u32 v252, s60, v252
  s_mov_b64 exec, 1
  buffer_load_dword v253, v252, s[92:95], 0 offen sc1
  s_mov_b64 exec, -1
L_pi_91:
  s_waitcnt lgkmcnt(4)
  v_mfma_f32_32x32x16_bf16 v[48:63], a[160:163], v[80:83], v[48:63]
  ds_read_b128 v[92:95], v3 offset:52224
  v_add_f32 v102, 1.0, v102
  v_add_f32 v103, 1.0, v103
  v_mfma_f32_32x32x16_bf16 v[64:79], a[164:167], v[80:83], v[64:79]
  v_rcp_f32 v96, v96
  v_rcp_f32 v97, v97
  s_waitcnt lgkmcnt(3)
  v_mfma_f32_32x32x16_bf16 v[48:63], a[168:171], v[84:87], v[48:63]
  ds_read_b128 v[80:83], v3 offset:53248
  v_rcp_f32 v98, v98
  v_rcp_f32 v99, v99
  v_mfma_f32_32x32x16_bf16 v[64:79], a[172:175], v[84:87], v[64:79]
  v_rcp_f32 v100, v100
  v_rcp_f32 v101, v101
  s_waitcnt lgkmcnt(2)
  v_mfma_f32_32x32x16_bf16 v[48:63], a[176:179], v[88:91], v[48:63]
  ds_read_b128 v[84:87], v3 offset:54272
  v_rcp_f32 v102, v102
  v_rcp_f32 v103, v103
  v_mfma_f32_32x32x16_bf16 v[64:79], a[180:183], v[88:91], v[64:79]
  v_mul_f32 v40, v40, v96
  v_mul_f32 v41, v41, v97
  v_mul_f32 v42, v42, v98
  s_waitcnt lgkmcnt(2)
  v_mfma_f32_32x32x16_bf16 v[48:63], a[184:187], v[92:95], v[48:63]
  ds_read_b128 v[88:91], v3 offset:55296
  v_mul_f32 v43, v43, v99
  v_mul_f32 v44, v44, v100
  v_mfma_f32_32x32x16_bf16 v[64:79], a[188:191], v[92:95], v[64:79]
  v_mul_f32 v45, v45, v101
  v_mul_f32 v46, v46, v102
  s_waitcnt lgkmcnt(2)
  v_mfma_f32_32x32x16_bf16 v[48:63], a[192:195], v[80:83], v[48:63]
  ds_read_b128 v[92:95], v3 offset:56320
  v_mul_f32 v47, v47, v103
  v_cvt_pk_bf16_f32 v24, v40, v41
  v_mfma_f32_32x32x16_bf16 v[64:79], a[196:199], v[80:83], v[64:79]
  v_cvt_pk_bf16_f32 v25, v42, v43
  v_cvt_pk_bf16_f32 v26, v44, v45
  s_waitcnt lgkmcnt(2)
  v_mfma_f32_32x32x16_bf16 v[48:63], a[200:203], v[84:87], v[48:63]
  v_cvt_pk_bf16_f32 v27, v46, v47
  buffer_store_dwordx4 v[24:27], v3, s[24:27], s41 offen offset:1024 sc1
  v_mfma_f32_32x32x16_bf16 v[64:79], a[204:207], v[84:87], v[64:79]
  s_waitcnt lgkmcnt(1)
  v_mfma_f32_32x32x16_bf16 v[48:63], a[208:211], v[88:91], v[48:63]
  v_mfma_f32_32x32x16_bf16 v[64:79], a[212:215], v[88:91], v[64:79]
  s_waitcnt lgkmcnt(0)
  v_mfma_f32_32x32x16_bf16 v[48:63], a[216:219], v[92:95], v[48:63]
  v_mfma_f32_32x32x16_bf16 v[64:79], a[220:223], v[92:95], v[64:79]
  s_cmp_lg_u32 s3, 0
  s_cbranch_scc1 L_pc_92
  s_waitcnt vmcnt(1)
  s_mov_b64 exec, 1
  v_cmp_le_u32 vcc, 14, v253
  s_nop 2
  s_cmp_eq_u64 vcc, exec
  s_mov_b64 exec, -1
  s_cbranch_scc1 L_pc_92
  s_cmp_lg_u32 s3, 0
  s_cbranch_scc1 L_wt_93
  v_lshlrev_b32 v250, 7, v2
  s_lshl_b32 s60, s56, 7
  v_add_u32 v250, s60, v250
  s_mov_b64 exec, 1
  s_mov_b32 s61, 0
L_pl_94:
  buffer_load_dword v251, v250, s[92:95], 0 offen sc1
  s_add_u32 s61, s61, 1
  s_waitcnt vmcnt(0)
  v_cmp_le_u32 vcc, 14, v251
  s_nop 2
  s_cmp_eq_u64 vcc, exec
  s_cbranch_scc1 L_pd_95
  s_sleep 6
  s_cmp_lt_u32 s61, 400000
  s_cbranch_scc1 L_pl_94
L_pd_95:
  s_mov_b64 exec, -1
L_wt_93:
L_pc_92:
  s_waitcnt lgkmcnt(0)
  s_barrier
  s_add_u32 s41, s32, 3
  s_mul_i32 s41, s41, 112*1024
  s_add_u32 s41, s41, s40
  v_mul_f32 v96, 0xbfb8aa3b, v48
  v_mul_f32 v97, 0xbfb8aa3b, v49
  v_mul_f32 v98, 0xbfb8aa3b, v50
  v_mul_f32 v99, 0xbfb8aa3b, v51
  v_mul_f32 v100, 0xbfb8aa3b, v52
  v_mul_f32 v101, 0xbfb8aa3b, v53
  v_mul_f32 v102, 0xbfb8aa3b, v54
  v_mul_f32 v103, 0xbfb8aa3b, v55
  v_exp_f32 v96, v96
  v_exp_f32 v97, v97
  v_exp_f32 v98, v98
  v_exp_f32 v99, v99
  v_exp_f32 v100, v100
  v_exp_f32 v101, v101
  v_exp_f32 v102, v102
  v_exp_f32 v103, v103
  v_mul_f32 v64, v48, v64
  v_mul_f32 v65, v49, v65
  v_mul_f32 v66, v50, v66
  v_mul_f32 v67, v51, v67
  v_mul_f32 v68, v52, v68
  v_mul_f32 v69, v53, v69
  v_mul_f32 v70, v54, v70
  v_mul_f32 v71, v55, v71
  v_add_f32 v96, 1.0, v96
  v_add_f32 v97, 1.0, v97
  v_add_f32 v98, 1.0, v98
  v_add_f32 v99, 1.0, v99
  v_add_f32 v100, 1.0, v100
  v_add_f32 v101, 1.0, v101
  v_add_f32 v102, 1.0, v102
  v_add_f32 v103, 1.0, v103
  v_rcp_f32 v96, v96
  v_rcp_f32 v97, v97
  v_rcp_f32 v98, v98
  v_rcp_f32 v99, v99
  v_rcp_f32 v100, v100
  v_rcp_f32 v101, v101
  v_rcp_f32 v102, v102
  v_rcp_f32 v103, v103
  v_mul_f32 v64, v64, v96
  v_mul_f32 v65, v65, v97
  v_mul_f32 v66, v66, v98
  v_mul_f32 v67, v67, v99
  v_mul_f32 v68, v68, v100
  v_mul_f32 v69, v69, v101
  v_mul_f32 v70, v70, v102
  v_mul_f32 v71, v71, v103
  v_cvt_pk_bf16_f32 v48, v64, v65
  v_cvt_pk_bf16_f32 v49, v66, v67
  v_cvt_pk_bf16_f32 v50, v68, v69
  v_cvt_pk_bf16_f32 v51, v70, v71
  buffer_store_dwordx4 v[48:51], v3, s[24:27], s41 offen offset:0 sc1
  v_mul_f32 v96, 0xbfb8aa3b, v56
  v_mul_f32 v97, 0xbfb8aa3b, v57
  v_mul_f32 v98, 0xbfb8aa3b, v58
  v_mul_f32 v99, 0xbfb8aa3b, v59
  v_mul_f32 v100, 0xbfb8aa3b, v60
  v_mul_f32 v101, 0xbfb8aa3b, v61
  v_mul_f32 v102, 0xbfb8aa3b, v62
  v_mul_f32 v103, 0xbfb8aa3b, v63
  v_exp_f32 v96, v96
  v_exp_f32 v97, v97
  v_exp_f32 v98, v98
  v_exp_f32 v99, v99
  v_exp_f32 v100, v100
  v_exp_f32 v101, v101
  v_exp_f32 v102, v102
  v_exp_f32 v103, v103
  v_mul_f32 v72, v56, v72
  v_mul_f32 v73, v57, v73
  v_mul_f32 v74, v58, v74
  v_mul_f32 v75, v59, v75
  v_mul_f32 v76, v60, v76
  v_mul_f32 v77, v61, v77
  v_mul_f32 v78, v62, v78
  v_mul_f32 v79, v63, v79
  v_add_f32 v96, 1.0, v96
  v_add_f32 v97, 1.0, v97
  v_add_f32 v98, 1.0, v98
  v_add_f32 v99, 1.0, v99
  v_add_f32 v100, 1.0, v100
  v_add_f32 v101, 1.0, v101
  v_add_f32 v102, 1.0, v102
  v_add_f32 v103, 1.0, v103
  v_rcp_f32 v96, v96
  v_rcp_f32 v97, v97
  v_rcp_f32 v98, v98
  v_rcp_f32 v99, v99
  v_rcp_f32 v100, v100
  v_rcp_f32 v101, v101
  v_rcp_f32 v102, v102
  v_rcp_f32 v103, v103
  v_mul_f32 v72, v72, v96
  v_mul_f32 v73, v73, v97
  v_mul_f32 v74, v74, v98
  v_mul_f32 v75, v75, v99
  v_mul_f32 v76, v76, v100
  v_mul_f32 v77, v77, v101
  v_mul_f32 v78, v78, v102
  v_mul_f32 v79, v79, v103
  v_cvt_pk_bf16_f32 v56, v72, v73
  v_cvt_pk_bf16_f32 v57, v74, v75
  v_cvt_pk_bf16_f32 v58, v76, v77
  v_cvt_pk_bf16_f32 v59, v78, v79
  buffer_store_dwordx4 v[56:59], v3, s[24:27], s41 offen offset:1024 sc1
  buffer_load_dwordx4 v[112:115], v3, s[24:27], s22 offen offset:0 sc1
  buffer_load_dwordx4 v[116:119], v3, s[24:27], s22 offen offset:1024 sc1
  buffer_load_dwordx4 v[120:123], v3, s[24:27], s22 offen offset:2048 sc1
  buffer_load_dwordx4 v[124:127], v3, s[24:27], s22 offen offset:3072 sc1
  s_add_u32 s22, s22, 4096
  buffer_load_dwordx4 v[128:131], v3, s[24:27], s22 offen offset:0 sc1
  buffer_load_dwordx4 v[132:135], v3, s[24:27], s22 offen offset:1024 sc1
  buffer_load_dwordx4 v[136:139], v3, s[24:27], s22 offen offset:2048 sc1
  buffer_load_dwordx4 v[140:143], v3, s[24:27], s22 offen offset:3072 sc1
  s_add_u32 s22, s22, 4096
  buffer_load_dwordx4 v[144:147], v3, s[24:27], s22 offen offset:0 sc1
  buffer_load_dwordx4 v[148:151], v3, s[24:27], s22 offen offset:1024 sc1
  buffer_load_dwordx4 v[152:155], v3, s[24:27], s22 offen offset:2048 sc1
  buffer_load_dwordx4 v[156:159], v3, s[24:27], s22 offen offset:3072 sc1
  s_add_u32 s22, s22, 4096
  buffer_load_dwordx4 v[160:163], v3, s[24:27], s22 offen offset:0 sc1
  buffer_load_dwordx4 v[164:167], v3, s[24:27], s22 offen offset:1024 sc1
  s_waitcnt vmcnt(14)
  s_barrier
  s_add_u32 s59, s33, 2
  s_cmp_lg_u32 s3, 0
  s_cbranch_scc1 L_sig_96
  v_lshlrev_b32 v250, 7, v2
  s_lshl_b32 s60, s59, 7
  v_add_u32 v250, s60, v250
  v_mov_b32 v251, 1
  s_mov_b64 exec, 3
  buffer_atomic_add v251, v250, s[92:95], 0 offen sc1
  s_mov_b64 exec, -1
L_sig_96:
  ds_read_b128 v[88:91], v6 offset:0
  ds_read_b128 v[92:95], v6 offset:1024
  ds_read_b128 v[96:99], v6 offset:2048
  s_add_u32 s16, s88, 0x600000
  s_addc_u32 s17, s89, 0
  s_mov_b32 s18, 0x1c0000
  s_mov_b32 s19, 0x20000
  v_and_b32 v4, 31, v2
  v_lshrrev_b32 v5, 5, v2
  s_and_b32 s13, s3, 1
  s_lshr_b32 s12, s3, 1
  s_lshl_b32 s14, s49, 12
  s_lshl_b32 s15, s13, 11
  s_add_u32 s14, s14, s15
  s_lshl_b32 s15, s12, 10
  s_add_u32 s14, s14, s15
  v_lshlrev_b32 v7, 9, v5
  v_lshl_add_u32 v7, v4, 4, v7
  v_add_u32 v7, s14, v7
  s_mul_i32 s34, s42, 28672
  s_mul_i32 s35, s43, 28672
  s_lshl_b32 s14, s3, 11
  v_add_u32 v8, s14, v3
  s_lshl_b32 s14, s3, 13
  v_add_u32 v9, s14, v3
  s_add_u32 s36, s88, 0xa00000
  s_addc_u32 s37, s89, 0
  s_mov_b32 s38, 0x1c0000
  s_mov_b32 s39, 0x20000
  v_mov_b32 v10, v7
  s_mov_b32 s40, s34
  s_mov_b32 s41, s35
  s_waitcnt vmcnt(13)
  v_mfma_f32_32x32x16_bf16 v[16:31], a[224:227], v[112:115], 0
  s_waitcnt lgkmcnt(2)
  v_mfma_f32_32x32x16_bf16 v[32:47], v[88:91], v[112:115], 0
  ds_read_b128 v[100:103], v6 offset:3072
  buffer_load_dwordx4 v[112:115], v3, s[24:27], s22 offen offset:2048 sc1
  s_waitcnt vmcnt(13)
  v_mfma_f32_32x32x16_bf16 v[16:31], a[228:231], v[116:119], v[16:31]
  s_waitcnt lgkmcnt(2)
  v_mfma_f32_32x32x16_bf16 v[32:47], v[92:95], v[116:119], v[32:47]
  ds_read_b128 v[88:91], v6 offset:4096
  buffer_load_dwordx4 v[116:119], v3, s[24:27], s22 offen offset:3072 sc1
  s_waitcnt vmcnt(13)
  v_mfma_f32_32x32x16_bf16 v[16:31], a[232:235], v[120:123], v[16:31]
  s_waitcnt lgkmcnt(2)
  v_mfma_f32_32x32x16_bf16 v[32:47], v[96:99], v[120:123], v[32:47]
  ds_read_b128 v[92:95], v6 offset:5120
  s_add_u32 s22, s22, 4096
  buffer_load_dwordx4 v[120:123], v3, s[24:27], s22 offen offset:0 sc1
  s_waitcnt vmcnt(13)
  v_mfma_f32_32x32x16_bf16 v[16:31], a[236:239], v[124:127], v[16:31]
  s_waitcnt lgkmcnt(2)
  v_mfma_f32_32x32x16_bf16 v[32:47], v[100:103], v[124:127], v[32:47]
  ds_read_b128 v[96:99], v6 offset:6144
  buffer_load_dwordx4 v[124:127], v3, s[24:27], s22 offen offset:1024 sc1
  s_waitcnt vmcnt(13)
  v_mfma_f32_32x32x16_bf16 v[16:31], a[240:243], v[128:131], v[16:31]
  s_waitcnt lgkmcnt(2)
  v_mfma_f32_32x32x16_bf16 v[32:47], v[88:91], v[128:131], v[32:47]
  ds_read_b128 v[100:103], v6 offset:7168
  buffer_load_dwordx4 v[128:131], v3, s[24:27], s22 offen offset:2048 sc1
  s_waitcnt vmcnt(13)
  v_mfma_f32_32x32x16_bf16 v[16:31], a[244:247], v[132:135], v[16:31]
  s_waitcnt lgkmcnt(2)
  v_mfma_f32_32x32x16_bf16 v[32:47], v[92:95], v[132:135], v[32:47]
  ds_read_b128 v[88:91], v6 offset:8192
  buffer_load_dwordx4 v[132:135], v3, s[24:27], s22 offen offset:3072 sc1
  s_waitcnt vmcnt(13)
  v_mfma_f32_32x32x16_bf16 v[16:31], a[248:251], v[136:139], v[16:31]
  s_waitcnt lgkmcnt(2)
  v_mfma_f32_32x32x16_bf16 v[32:47], v[96:99], v[136:139], v[32:47]
  ds_read_b128 v[92:95], v6 offset:9216
  s_add_u32 s22, s22, 4096
  buffer_load_dwordx4 v[136:139], v3, s[24:27], s22 offen offset:0 sc1
  s_waitcnt vmcnt(13)
  v_mfma_f32_32x32x16_bf16 v[16:31], a[252:255], v[140:143], v[16:31]
  s_waitcnt lgkmcnt(2)
  v_mfma_f32_32x32x16_bf16 v[32:47], v[100:103], v[140:143], v[32:47]
  ds_read_b128 v[96:99], v6 offset:10240
  buffer_load_dwordx4 v[140:143], v3, s[24:27], s22 offen offset:1024 sc1
  s_waitcnt vmcnt(13)
  v_mfma_f32_32x32x16_bf16 v[16:31], v[168:171], v[144:147], v[16:31]
  s_waitcnt lgkmcnt(2)
  v_mfma_f32_32x32x16_bf16 v[32:47], v[88:91], v[144:147], v[32:47]
  ds_read_b128 v[100:103], v6 offset:11264
  buffer_load_dwordx4 v[144:147], v3, s[24:27], s22 offen offset:2048 sc1
  s_waitcnt vmcnt(13)
  v_mfma_f32_32x32x16_bf16 v[16:31], v[172:175], v[148:151], v[16:31]
  s_waitcnt lgkmcnt(2)
  v_mfma_f32_32x32x16_bf16 v[32:47], v[92:95], v[148:151], v[32:47]
  ds_read_b128 v[88:91], v6 offset:12288
  buffer_load_dwordx4 v[148:151], v3, s[24:27], s22 offen offset:3072 sc1
  s_waitcnt vmcnt(13)
  v_mfma_f32_32x32x16_bf16 v[16:31], v[176:179], v[152:155], v[16:31]
  s_waitcnt lgkmcnt(2)
  v_mfma_f32_32x32x16_bf16 v[32:47], v[96:99], v[152:155], v[32:47]
  ds_read_b128 v[92:95], v6 offset:13312
  s_add_u32 s22, s22, 4096
  buffer_load_dwordx4 v[152:155], v3, s[24:27], s22 offen offset:0 sc1
  s_waitcnt vmcnt(13)
  v_mfma_f32_32x32x16_bf16 v[16:31], v[180:183], v[156:159], v[16:31]
  s_waitcnt lgkmcnt(2)
  v_mfma_f32_32x32x16_bf16 v[32:47], v[100:103], v[156:159], v[32:47]
  ds_read_b128 v[96:99], v6 offset:14336
  buffer_load_dwordx4 v[156:159], v3, s[24:27], s22 offen offset:1024 sc1
  s_waitcnt vmcnt(13)
  v_mfma_f32_32x32x16_bf16 v[16:31], v[184:187], v[160:163], v[16:31]
  s_waitcnt lgkmcnt(2)
  v_mfma_f32_32x32x16_bf16 v[32:47], v[88:91], v[160:163], v[32:47]
  ds_read_b128 v[100:103], v6 offset:15360
  buffer_load_dwordx4 v[160:163], v3, s[24:27], s22 offen offset:2048 sc1
  s_waitcnt vmcnt(13)
  v_mfma_f32_32x32x16_bf16 v[16:31], v[188:191], v[164:167], v[16:31]
  s_waitcnt lgkmcnt(2)
  v_mfma_f32_32x32x16_bf16 v[32:47], v[92:95], v[164:167], v[32:47]
  ds_read_b128 v[88:91], v6 offset:16384
  buffer_load_dwordx4 v[164:167], v3, s[24:27], s22 offen offset:3072 sc1
  s_cmp_lg_u32 s3, 0
  s_cbranch_scc1 L_wt_97
  v_lshlrev_b32 v250, 7, v2
  s_lshl_b32 s60, s57, 7
  v_add_u32 v250, s60, v250
  s_mov_b64 exec, 1
  s_mov_b32 s61, 0
L_pl_98:
  buffer_load_dword v251, v250, s[92:95], 0 offen sc1
  s_add_u32 s61, s61, 1
  s_waitcnt vmcnt(0)
  v_cmp_le_u32 vcc, 14, v251
  s_nop 2
  s_cmp_eq_u64 vcc, exec
  s_cbranch_scc1 L_pd_99
  s_sleep 6
  s_cmp_lt_u32 s61, 400000
  s_cbranch_scc1 L_pl_98
L_pd_99:
  s_mov_b64 exec, -1
L_wt_97:
  s_barrier
  buffer_load_dwordx4 v[80:83], v7, s[16:19], s34 offen sc1
  buffer_load_dwordx4 v[84:87], v7, s[16:19], s35 offen sc1
  s_waitcnt vmcnt(15)
  v_mfma_f32_32x32x16_bf16 v[16:31], v[192:195], v[112:115], v[16:31]
  s_waitcnt lgkmcnt(2)
  v_mfma_f32_32x32x16_bf16 v[32:47], v[96:99], v[112:115], v[32:47]
  ds_read_b128 v[92:95], v6 offset:17408
  buffer_load_dwordx4 v[112:115], v3, s[24:27], s23 offen offset:0 sc1
  s_waitcnt vmcnt(15)
  v_mfma_f32_32x32x16_bf16 v[16:31], v[196:199], v[116:119], v[16:31]
  s_waitcnt lgkmcnt(2)
  v_mfma_f32_32x32x16_bf16 v[32:47], v[100:103], v[116:119], v[32:47]
  ds_read_b128 v[96:99], v6 offset:18432
  buffer_load_dwordx4 v[116:119], v3, s[24:27], s23 offen offset:1024 sc1
  s_waitcnt vmcnt(15)
  v_mfma_f32_32x32x16_bf16 v[16:31], v[200:203], v[120:123], v[16:31]
  s_waitcnt lgkmcnt(2)
  v_mfma_f32_32x32x16_bf16 v[32:47], v[88:91], v[120:123], v[32:47]
  ds_read_b128 v[100:103], v6 offset:19456
  buffer_load_dwordx4 v[120:123], v3, s[24:27], s23 offen offset:2048 sc1
  s_waitcnt vmcnt(15)
  v_mfma_f32_32x32x16_bf16 v[16:31], v[204:207], v[124:127], v[16:31]
  s_waitcnt lgkmcnt(2)
  v_mfma_f32_32x32x16_bf16 v[32:47], v[92:95], v[124:127], v[32:47]
  ds_read_b128 v[88:91], v6 offset:20480
  buffer_load_dwordx4 v[124:127], v3, s[24:27], s23 offen offset:3072 sc1
  s_waitcnt vmcnt(15)
  v_mfma_f32_32x32x16_bf16 v[16:31], v[208:211], v[128:131], v[16:31]
  s_waitcnt lgkmcnt(2)
  v_mfma_f32_32x32x16_bf16 v[32:47], v[96:99], v[128:131], v[32:47]
  ds_read_b128 v[92:95], v6 offset:21504
  s_add_u32 s23, s23, 4096
  buffer_load_dwordx4 v[128:131], v3, s[24:27], s23 offen offset:0 sc1
  s_waitcnt vmcnt(15)
  v_mfma_f32_32x32x16_bf16 v[16:31], v[212:215], v[132:135], v[16:31]
  s_waitcnt lgkmcnt(2)
  v_mfma_f32_32x32x16_bf16 v[32:47], v[100:103], v[132:135], v[32:47]
  ds_read_b128 v[96:99], v6 offset:22528
  buffer_load_dwordx4 v[132:135], v3, s[24:27], s23 offen offset:1024 sc1
  s_waitcnt vmcnt(15)
  v_mfma_f32_32x32x16_bf16 v[16:31], v[216:219], v[136:139], v[16:31]
  s_waitcnt lgkmcnt(2)
  v_mfma_f32_32x32x16_bf16 v[32:47], v[88:91], v[136:139], v[32:47]
  ds_read_b128 v[100:103], v6 offset:23552
  buffer_load_dwordx4 v[136:139], v3, s[24:27], s23 offen offset:2048 sc1
  s_waitcnt vmcnt(15)
  v_mfma_f32_32x32x16_bf16 v[16:31], v[220:223], v[140:143], v[16:31]
  s_waitcnt lgkmcnt(2)
  v_mfma_f32_32x32x16_bf16 v[32:47], v[92:95], v[140:143], v[32:47]
  ds_read_b128 v[88:91], v6 offset:24576
  buffer_load_dwordx4 v[140:143], v3, s[24:27], s23 offen offset:3072 sc1
  s_waitcnt vmcnt(15)
  v_mfma_f32_32x32x16_bf16 v[16:31], v[224:227], v[144:147], v[16:31]
  s_waitcnt lgkmcnt(2)
  v_mfma_f32_32x32x16_bf16 v[32:47], v[96:99], v[144:147], v[32:47]
  ds_read_b128 v[92:95], v6 offset:25600
  s_add_u32 s23, s23, 4096
  buffer_load_dwordx4 v[144:147], v3, s[24:27], s23 offen offset:0 sc1
  s_waitcnt vmcnt(15)
  v_mfma_f32_32x32x16_bf16 v[16:31], v[228:231], v[148:151], v[16:31]
  s_waitcnt lgkmcnt(2)
  v_mfma_f32_32x32x16_bf16 v[32:47], v[100:103], v[148:151], v[32:47]
  buffer_load_dwordx4 v[148:151], v3, s[24:27], s23 offen offset:1024 sc1
  s_waitcnt vmcnt(15)
  v_mfma_f32_32x32x16_bf16 v[16:31], v[232:235], v[152:155], v[16:31]
  s_waitcnt lgkmcnt(1)
  v_mfma_f32_32x32x16_bf16 v[32:47], v[88:91], v[152:155], v[32:47]
  buffer_load_dwordx4 v[152:155], v3, s[24:27], s23 offen offset:2048 sc1
  s_waitcnt vmcnt(15)
  v_mfma_f32_32x32x16_bf16 v[16:31], v[236:239], v[156:159], v[16:31]
  s_waitcnt lgkmcnt(0)
  v_mfma_f32_32x32x16_bf16 v[32:47], v[92:95], v[156:159], v[32:47]
  ds_read_b128 v[88:91], v6 offset:0
  buffer_load_dwordx4 v[156:159], v3, s[24:27], s23 offen offset:3072 sc1
  s_waitcnt vmcnt(15)
  v_mfma_f32_32x32x16_bf16 v[16:31], v[240:243], v[160:163], v[16:31]
  v_mfma_f32_32x32x16_bf16 v[32:47], v[104:107], v[160:163], v[32:47]
  ds_read_b128 v[92:95], v6 offset:1024
  s_add_u32 s23, s23, 4096
  buffer_load_dwordx4 v[160:163], v3, s[24:27], s23 offen offset:0 sc1
  s_waitcnt vmcnt(15)
  v_mfma_f32_32x32x16_bf16 v[16:31], v[244:247], v[164:167], v[16:31]
  v_mfma_f32_32x32x16_bf16 v[32:47], v[108:111], v[164:167], v[32:47]
  ds_read_b128 v[96:99], v6 offset:2048
  buffer_load_dwordx4 v[164:167], v3, s[24:27], s23 offen offset:1024 sc1
  s_waitcnt vmcnt(13)
  v_mfma_f32_32x32x16_bf16 v[48:63], a[224:227], v[112:115], 0
  s_waitcnt lgkmcnt(2)
  v_mfma_f32_32x32x16_bf16 v[64:79], v[88:91], v[112:115], 0
  ds_read_b128 v[100:103], v6 offset:3072
  buffer_load_dwordx4 v[112:115], v3, s[24:27], s23 offen offset:2048 sc1
  s_waitcnt vmcnt(13)
  v_mfma_f32_32x32x16_bf16 v[48:63], a[228:231], v[116:119], v[48:63]
  s_nop 0
  ds_write_b128 v8, v[16:19] offset:0
  s_waitcnt lgkmcnt(3)
  v_mfma_f32_32x32x16_bf16 v[64:79], v[92:95], v[116:119], v[64:79]
  ds_read_b128 v[88:91], v6 offset:4096
  ds_write_b128 v8, v[20:23] offset:1024
  buffer_load_dwordx4 v[116:119], v3, s[24:27], s23 offen offset:3072 sc1
  s_waitcnt vmcnt(13)
  v_mfma_f32_32x32x16_bf16 v[48:63], a[232:235], v[120:123], v[48:63]
  ds_write_b128 v8, v[32:35] offset:8192
  s_waitcnt lgkmcnt(5)
  v_mfma_f32_32x32x16_bf16 v[64:79], v[96:99], v[120:123], v[64:79]
  ds_read_b128 v[92:95], v6 offset:5120
  ds_write_b128 v8, v[36:39] offset:9216
  s_add_u32 s23, s23, 4096
  buffer_load_dwordx4 v[120:123], v3, s[24:27], s23 offen offset:0 sc1
  s_waitcnt vmcnt(13)
  v_mfma_f32_32x32x16_bf16 v[48:63], a[236:239], v[124:127], v[48:63]
  ds_write_b128 v8, v[24:27] offset:16384
  s_waitcnt lgkmcnt(7)
  v_mfma_f32_32x32x16_bf16 v[64:79], v[100:103], v[124:127], v[64:79]
  ds_read_b128 v[96:99], v6 offset:6144
  ds_write_b128 v8, v[28:31] offset:17408
  buffer_load_dwordx4 v[124:127], v3, s[24:27], s23 offen offset:1024 sc1
  s_waitcnt vmcnt(13)
  v_mfma_f32_32x32x16_bf16 v[48:63], a[240:243], v[128:131], v[48:63]
  ds_write_b128 v8, v[40:43] offset:24576
  s_waitcnt lgkmcnt(8)
  v_mfma_f32_32x32x16_bf16 v[64:79], v[88:91], v[128:131], v[64:79]
  ds_read_b128 v[100:103], v6 offset:7168
  ds_write_b128 v8, v[44:47] offset:25600
  buffer_load_dwordx4 v[128:131], v3, s[24:27], s23 offen offset:2048 sc1
  s_waitcnt vmcnt(13)
  v_mfma_f32_32x32x16_bf16 v[48:63], a[244:247], v[132:135], v[48:63]
  s_waitcnt lgkmcnt(7)
  v_mfma_f32_32x32x16_bf16 v[64:79], v[92:95], v[132:135], v[64:79]
  ds_read_b128 v[88:91], v6 offset:8192
  s_waitcnt lgkmcnt(1)
  s_barrier
  buffer_load_dwordx4 v[132:135], v3, s[24:27], s23 offen offset:3072 sc1
  s_waitcnt vmcnt(13)
  v_mfma_f32_32x32x16_bf16 v[48:63], a[248:251], v[136:139], v[48:63]
  ds_read_b128 v[16:19], v9 offset:0
  ds_read_b128 v[20:23], v9 offset:1024
  ds_read_b128 v[24:27], v9 offset:2048
  ds_read_b128 v[28:31], v9 offset:3072
  v_mfma_f32_32x32x16_bf16 v[64:79], v[96:99], v[136:139], v[64:79]
  ds_read_b128 v[92:95], v6 offset:9216
  ds_read_b128 v[32:35], v9 offset:4096
  ds_read_b128 v[36:39], v9 offset:5120
  ds_read_b128 v[40:43], v9 offset:6144
  ds_read_b128 v[44:47], v9 offset:7168
  s_add_u32 s23, s23, 4096
  buffer_load_dwordx4 v[136:139], v3, s[24:27], s23 offen offset:0 sc1
  s_waitcnt vmcnt(13)
  v_mfma_f32_32x32x16_bf16 v[48:63], a[252:255], v[140:143], v[48:63]
  s_waitcnt lgkmcnt(5)
  v_add_f32 v16, v16, v24
  v_add_f32 v17, v17, v25
  v_mfma_f32_32x32x16_bf16 v[64:79], v[100:103], v[140:143], v[64:79]
  ds_read_b128 v[96:99], v6 offset:10240
  v_add_f32 v18, v18, v26
  v_add_f32 v19, v19, v27
  v_add_f32 v20, v20, v28
  v_add_f32 v21, v21, v29
  buffer_load_dwordx4 v[140:143], v3, s[24:27], s23 offen offset:1024 sc1
  s_waitcnt vmcnt(13)
  v_mfma_f32_32x32x16_bf16 v[48:63], v[168:171], v[144:147], v[48:63]
  v_add_f32 v22, v22, v30
  v_add_f32 v23, v23, v31
  s_waitcnt lgkmcnt(1)
  v_add_f32 v32, v32, v40
  v_mfma_f32_32x32x16_bf16 v[64:79], v[88:91], v[144:147], v[64:79]
  ds_read_b128 v[100:103], v6 offset:11264
  v_add_f32 v33, v33, v41
  v_add_f32 v34, v34, v42
  v_add_f32 v35, v35, v43
  buffer_load_dwordx4 v[144:147], v3, s[24:27], s23 offen offset:2048 sc1
  s_waitcnt vmcnt(13)
  v_mfma_f32_32x32x16_bf16 v[48:63], v[172:175], v[148:151], v[48:63]
  v_add_f32 v36, v36, v44
  v_add_f32 v37, v37, v45
  v_add_f32 v38, v38, v46
  v_add_f32 v39, v39, v47
  v_mfma_f32_32x32x16_bf16 v[64:79], v[92:95], v[148:151], v[64:79]
  ds_read_b128 v[88:91], v6 offset:12288
  v_add_f32 v16, v16, v32
  v_add_f32 v17, v17, v33
  v_add_f32 v18, v18, v34
  buffer_load_dwordx4 v[148:151], v3, s[24:27], s23 offen offset:3072 sc1
  s_waitcnt vmcnt(13)
  v_mfma_f32_32x32x16_bf16 v[48:63], v[176:179], v[152:155], v[48:63]
  v_add_f32 v19, v19, v35
  v_add_f32 v20, v20, v36
  v_add_f32 v21, v21, v37
  v_add_f32 v22, v22, v38
  s_waitcnt lgkmcnt(2)
  v_mfma_f32_32x32x16_bf16 v[64:79], v[96:99], v[152:155], v[64:79]
  ds_read_b128 v[92:95], v6 offset:13312
  v_add_f32 v23, v23, v39
  v_permlane32_swap_b32 v16, v20
  v_permlane32_swap_b32 v17, v21
  v_permlane32_swap_b32 v18, v22
  s_add_u32 s23, s23, 4096
  buffer_load_dwordx4 v[152:155], v3, s[24:27], s23 offen offset:0 sc1
  s_waitcnt vmcnt(13)
  v_mfma_f32_32x32x16_bf16 v[48:63], v[180:183], v[156:159], v[48:63]
  v_permlane32_swap_b32 v19, v23
  v_lshlrev_b32 v24, 16, v80
  v_and_b32 v25, 0xffff0000, v80
  s_waitcnt lgkmcnt(2)
  v_mfma_f32_32x32x16_bf16 v[64:79], v[100:103], v[156:159], v[64:79]
  ds_read_b128 v[96:99], v6 offset:14336
  v_add_f32 v16, v16, v24
  v_add_f32 v17, v17, v25
  v_lshlrev_b32 v24, 16, v81
  v_and_b32 v25, 0xffff0000, v81
  buffer_load_dwordx4 v[156:159], v3, s[24:27], s23 offen offset:1024 sc1
  s_waitcnt vmcnt(13)
  v_mfma_f32_32x32x16_bf16 v[48:63], v[184:187], v[160:163], v[48:63]
  v_add_f32 v18, v18, v24
  v_add_f32 v19, v19, v25
  v_lshlrev_b32 v24, 16, v82
  v_and_b32 v25, 0xffff0000, v82
  s_waitcnt lgkmcnt(2)
  v_mfma_f32_32x32x16_bf16 v[64:79], v[88:91], v[160:163], v[64:79]
  ds_read_b128 v[100:103], v6 offset:15360
  v_add_f32 v20, v20, v24
  v_add_f32 v21, v21, v25
  v_lshlrev_b32 v24, 16, v83
  buffer_load_dwordx4 v[160:163], v3, s[24:27], s23 offen offset:2048 sc1
  s_waitcnt vmcnt(13)
  v_mfma_f32_32x32x16_bf16 v[48:63], v[188:191], v[164:167], v[48:63]
  v_and_b32 v25, 0xffff0000, v83
  v_add_f32 v22, v22, v24
  v_add_f32 v23, v23, v25
  v_cvt_pk_bf16_f32 v28, v16, v17
  s_waitcnt lgkmcnt(2)
  v_mfma_f32_32x32x16_bf16 v[64:79], v[92:95], v[164:167], v[64:79]
  ds_read_b128 v[88:91], v6 offset:16384
  v_cvt_pk_bf16_f32 v29, v18, v19
  v_cvt_pk_bf16_f32 v30, v20, v21
  v_cvt_pk_bf16_f32 v31, v22, v23
  buffer_load_dwordx4 v[164:167], v3, s[24:27], s23 offen offset:3072 sc1
  buffer_store_dwordx4 v[28:31], v10, s[36:39], s40 offen sc1
  s_waitcnt vmcnt(14)
  v_mfma_f32_32x32x16_bf16 v[48:63], v[192:195], v[112:115], v[48:63]
  s_waitcnt lgkmcnt(2)
  v_mfma_f32_32x32x16_bf16 v[64:79], v[96:99], v[112:115], v[64:79]
  ds_read_b128 v[92:95], v6 offset:17408
  s_waitcnt vmcnt(13)
  v_mfma_f32_32x32x16_bf16 v[48:63], v[196:199], v[116:119], v[48:63]
  s_waitcnt lgkmcnt(2)
  v_mfma_f32_32x32x16_bf16 v[64:79], v[100:103], v[116:119], v[64:79]
  ds_read_b128 v[96:99], v6 offset:18432
  s_waitcnt vmcnt(12)
  v_mfma_f32_32x32x16_bf16 v[48:63], v[200:203], v[120:123], v[48:63]
  s_waitcnt lgkmcnt(2)
  v_mfma_f32_32x32x16_bf16 v[64:79], v[88:91], v[120:123], v[64:79]
  ds_read_b128 v[100:103], v6 offset:19456
  s_waitcnt vmcnt(11)
  v_mfma_f32_32x32x16_bf16 v[48:63], v[204:207], v[124:127], v[48:63]
  s_waitcnt lgkmcnt(2)
  v_mfma_f32_32x32x16_bf16 v[64:79], v[92:95], v[124:127], v[64:79]
  ds_read_b128 v[88:91], v6 offset:20480
  s_waitcnt vmcnt(10)
  v_mfma_f32_32x32x16_bf16 v[48:63], v[208:211], v[128:131], v[48:63]
  s_waitcnt lgkmcnt(2)
  v_mfma_f32_32x32x16_bf16 v[64:79], v[96:99], v[128:131], v[64:79]
  ds_read_b128 v[92:95], v6 offset:21504
  s_waitcnt vmcnt(9)
  v_mfma_f32_32x32x16_bf16 v[48:63], v[212:215], v[132:135], v[48:63]
  s_waitcnt lgkmcnt(2)
  v_mfma_f32_32x32x16_bf16 v[64:79], v[100:103], v[132:135], v[64:79]
  ds_read_b128 v[96:99], v6 offset:22528
  s_waitcnt vmcnt(8)
  v_mfma_f32_32x32x16_bf16 v[48:63], v[216:219], v[136:139], v[48:63]
  s_waitcnt lgkmcnt(2)
  v_mfma_f32_32x32x16_bf16 v[64:79], v[88:91], v[136:139], v[64:79]
  ds_read_b128 v[100:103], v6 offset:23552
  s_barrier
  s_waitcnt vmcnt(7)
  v_mfma_f32_32x32x16_bf16 v[48:63], v[220:223], v[140:143], v[48:63]
  s_waitcnt lgkmcnt(2)
  v_mfma_f32_32x32x16_bf16 v[64:79], v[92:95], v[140:143], v[64:79]
  ds_read_b128 v[88:91], v6 offset:24576
  s_waitcnt vmcnt(6)
  v_mfma_f32_32x32x16_bf16 v[48:63], v[224:227], v[144:147], v[48:63]
  s_waitcnt lgkmcnt(2)
  v_mfma_f32_32x32x16_bf16 v[64:79], v[96:99], v[144:147], v[64:79]
  ds_read_b128 v[92:95], v6 offset:25600
  s_waitcnt vmcnt(5)
  v_mfma_f32_32x32x16_bf16 v[48:63], v[228:231], v[148:151], v[48:63]
  s_waitcnt lgkmcnt(2)
  v_mfma_f32_32x32x16_bf16 v[64:79], v[100:103], v[148:151], v[64:79]
  s_waitcnt vmcnt(4)
  v_mfma_f32_32x32x16_bf16 v[48:63], v[232:235], v[152:155], v[48:63]
  s_waitcnt lgkmcnt(1)
  v_mfma_f32_32x32x16_bf16 v[64:79], v[88:91], v[152:155], v[64:79]
  s_waitcnt vmcnt(3)
  v_mfma_f32_32x32x16_bf16 v[48:63], v[236:239], v[156:159], v[48:63]
  s_waitcnt lgkmcnt(0)
  v_mfma_f32_32x32x16_bf16 v[64:79], v[92:95], v[156:159], v[64:79]
  s_waitcnt vmcnt(2)
  v_mfma_f32_32x32x16_bf16 v[48:63], v[240:243], v[160:163], v[48:63]
  v_mfma_f32_32x32x16_bf16 v[64:79], v[104:107], v[160:163], v[64:79]
  s_waitcnt vmcnt(1)
  v_mfma_f32_32x32x16_bf16 v[48:63], v[244:247], v[164:167], v[48:63]
  v_mfma_f32_32x32x16_bf16 v[64:79], v[108:111], v[164:167], v[64:79]
  s_nop 10
  ds_write_b128 v8, v[48:51] offset:0
  ds_write_b128 v8, v[52:55] offset:1024
  ds_write_b128 v8, v[64:67] offset:8192
  ds_write_b128 v8, v[68:71] offset:9216
  ds_write_b128 v8, v[56:59] offset:16384
  ds_write_b128 v8, v[60:63] offset:17408
  ds_write_b128 v8, v[72:75] offset:24576
  ds_write_b128 v8, v[76:79] offset:25600
  s_waitcnt vmcnt(0)
  s_waitcnt lgkmcnt(0)
  s_barrier
  s_add_u32 s59, s42, 160
  s_cmp_lg_u32 s3, 0
  s_cbranch_scc1 L_sig_100
  v_lshlrev_b32 v250, 7, v2
  s_lshl_b32 s60, s59, 7
  v_add_u32 v250, s60, v250
  v_mov_b32 v251, 1
  s_mov_b64 exec, 1
  buffer_atomic_add v251, v250, s[92:95], 0 offen sc1
  s_mov_b64 exec, -1
L_sig_100:
  ds_read_b128 v[48:51], v9 offset:0
  ds_read_b128 v[52:55], v9 offset:1024
  ds_read_b128 v[56:59], v9 offset:2048
  ds_read_b128 v[60:63], v9 offset:3072
  ds_read_b128 v[64:67], v9 offset:4096
  ds_read_b128 v[68:71], v9 offset:5120
  ds_read_b128 v[72:75], v9 offset:6144
  ds_read_b128 v[76:79], v9 offset:7168
  s_waitcnt lgkmcnt(4)
  v_add_f32 v48, v48, v56
  v_add_f32 v49, v49, v57
  v_add_f32 v50, v50, v58
  v_add_f32 v51, v51, v59
  v_add_f32 v52, v52, v60
  v_add_f32 v53, v53, v61
  v_add_f32 v54, v54, v62
  v_add_f32 v55, v55, v63
  s_waitcnt lgkmcnt(0)
  v_add_f32 v64, v64, v72
  v_add_f32 v65, v65, v73
  v_add_f32 v66, v66, v74
  v_add_f32 v67, v67, v75
  v_add_f32 v68, v68, v76
  v_add_f32 v69, v69, v77
  v_add_f32 v70, v70, v78
  v_add_f32 v71, v71, v79
  v_add_f32 v48, v48, v64
  v_add_f32 v49, v49, v65
  v_add_f32 v50, v50, v66
  v_add_f32 v51, v51, v67
  v_add_f32 v52, v52, v68
  v_add_f32 v53, v53, v69
  v_add_f32 v54, v54, v70
  v_add_f32 v55, v55, v71
  v_permlane32_swap_b32 v48, v52
  v_permlane32_swap_b32 v49, v53
  v_permlane32_swap_b32 v50, v54
  v_permlane32_swap_b32 v51, v55
  v_lshlrev_b32 v56, 16, v84
  v_and_b32 v57, 0xffff0000, v84
  v_add_f32 v48, v48, v56
  v_add_f32 v49, v49, v57
  v_lshlrev_b32 v56, 16, v85
  v_and_b32 v57, 0xffff0000, v85
  v_add_f32 v50, v50, v56
  v_add_f32 v51, v51, v57
  v_lshlrev_b32 v56, 16, v86
  v_and_b32 v57, 0xffff0000, v86
  v_add_f32 v52, v52, v56
  v_add_f32 v53, v53, v57
  v_lshlrev_b32 v56, 16, v87
  v_and_b32 v57, 0xffff0000, v87
  v_add_f32 v54, v54, v56
  v_add_f32 v55, v55, v57
  v_cvt_pk_bf16_f32 v60, v48, v49
  v_cvt_pk_bf16_f32 v61, v50, v51
  v_cvt_pk_bf16_f32 v62, v52, v53
  v_cvt_pk_bf16_f32 v63, v54, v55
  buffer_store_dwordx4 v[60:63], v10, s[36:39], s41 offen sc1
  s_add_u32 s59, s43, 160
  s_waitcnt vmcnt(0)
  s_waitcnt lgkmcnt(0)
  s_barrier
  s_cmp_lg_u32 s3, 0
  s_cbranch_scc1 L_sig_101
  v_lshlrev_b32 v250, 7, v2
  s_lshl_b32 s60, s59, 7
  v_add_u32 v250, s60, v250
  v_mov_b32 v251, 1
  s_mov_b64 exec, 1
  buffer_atomic_add v251, v250, s[92:95], 0 offen sc1
  s_mov_b64 exec, -1
L_sig_101:
L_gskip_80:
  v_and_b32 v33, 7, v2
  v_lshrrev_b32 v4, 3, v2
  s_mul_i32 s12, s3, 14
  v_add_u32 v5, s12, v4
  s_lshr_b32 s13, s2, 2
  s_mul_i32 s13, s13, 28672
  s_and_b32 s14, s2, 3
  s_lshl_b32 s14, s14, 7
  s_add_u32 s13, s13, s14
  v_lshlrev_b32 v6, 9, v5
  v_lshl_add_u32 v6, v33, 4, v6
  v_add_u32 v6, s13, v6
  v_add_u32 v7, 4096, v6
  v_mov_b32 v8, 0x80000000
  v_cmp_gt_u32 vcc, 6, v4
  v_cmp_gt_u32 s[38:39], 6, v4
  s_nop 0
  v_cndmask_b32 v7, v8, v7, vcc
  v_lshlrev_b32 v15, 3, v33
  v_add_u32 v15, 8064, v15
  s_lshl_b32 s37, s3, 6
  v_add_u32 v32, s37, v15
  s_add_u32 s24, s88, 0x400000
  s_addc_u32 s25, s89, 0
  s_mov_b32 s26, 0x1c0000
  s_mov_b32 s27, 0x20000
  buffer_load_dwordx4 v[24:27], v6, s[24:27], 0 offen sc1
  buffer_load_dwordx4 v[28:31], v7, s[24:27], 0 offen sc1
  s_add_u32 s16, s88, 0xe00000
  s_addc_u32 s17, s89, 0
  s_mov_b32 s18, 0x1c0000
  s_mov_b32 s19, 0x20000
  s_add_u32 s20, s88, 0xc00000
  s_addc_u32 s21, s89, 0
  s_mov_b32 s22, 0x1c0000
  s_mov_b32 s23, 0x20000
  s_add_u32 s28, s88, 0xa00000
  s_addc_u32 s29, s89, 0
  s_mov_b32 s30, 0x1c0000
  s_mov_b32 s31, 0x20000
  s_lshr_b32 s59, s2, 2
  s_add_u32 s59, s59, 160
  s_cmp_lg_u32 s3, 0
  s_cbranch_scc1 L_wt_102
  v_lshlrev_b32 v250, 7, v2
  s_lshl_b32 s60, s59, 7
  v_add_u32 v250, s60, v250
  s_mov_b64 exec, 1
  s_mov_b32 s61, 0
L_pl_103:
  buffer_load_dword v251, v250, s[92:95], 0 offen sc1
  s_add_u32 s61, s61, 1
  s_waitcnt vmcnt(0)
  v_cmp_le_u32 vcc, 7, v251
  s_nop 2
  s_cmp_eq_u64 vcc, exec
  s_cbranch_scc1 L_pd_104
  s_sleep 6
  s_cmp_lt_u32 s61, 400000
  s_cbranch_scc1 L_pl_103
L_pd_104:
  s_mov_b64 exec, -1
L_wt_102:
  s_barrier
  buffer_load_dwordx4 v[16:19], v6, s[28:31], 0 offen sc1
  buffer_load_dwordx4 v[20:23], v7, s[28:31], 0 offen sc1
  s_waitcnt vmcnt(0)
  v_lshlrev_b32 v52, 16, v24
  v_and_b32 v53, 0xffff0000, v24
  v_lshlrev_b32 v54, 16, v25
  v_and_b32 v55, 0xffff0000, v25
  v_lshlrev_b32 v56, 16, v26
  v_and_b32 v57, 0xffff0000, v26
  v_lshlrev_b32 v58, 16, v27
  v_and_b32 v59, 0xffff0000, v27
  v_lshlrev_b32 v60, 16, v28
  v_and_b32 v61, 0xffff0000, v28
  v_lshlrev_b32 v62, 16, v29
  v_and_b32 v63, 0xffff0000, v29
  v_lshlrev_b32 v64, 16, v30
  v_and_b32 v65, 0xffff0000, v30
  v_lshlrev_b32 v66, 16, v31
  v_and_b32 v67, 0xffff0000, v31
  v_lshlrev_b32 v36, 16, v16
  v_and_b32 v37, 0xffff0000, v16
  v_lshlrev_b32 v38, 16, v17
  v_and_b32 v39, 0xffff0000, v17
  v_lshlrev_b32 v40, 16, v18
  v_and_b32 v41, 0xffff0000, v18
  v_lshlrev_b32 v42, 16, v19
  v_and_b32 v43, 0xffff0000, v19
  v_lshlrev_b32 v44, 16, v20
  v_and_b32 v45, 0xffff0000, v20
  v_lshlrev_b32 v46, 16, v21
  v_and_b32 v47, 0xffff0000, v21
  v_lshlrev_b32 v48, 16, v22
  v_and_b32 v49, 0xffff0000, v22
  v_lshlrev_b32 v50, 16, v23
  v_and_b32 v51, 0xffff0000, v23
  v_add_f32 v84, v36, v37
  v_mul_f32 v85, v36, v36
  v_add_f32 v86, v38, v39
  v_mul_f32 v87, v37, v37
  v_fmac_f32 v85, v38, v38
  v_fmac_f32 v87, v39, v39
  v_add_f32 v84, v84, v40
  v_add_f32 v86, v86, v41
  v_fmac_f32 v85, v40, v40
  v_fmac_f32 v87, v41, v41
  v_add_f32 v84, v84, v42
  v_add_f32 v86, v86, v43
  v_fmac_f32 v85, v42, v42
  v_fmac_f32 v87, v43, v43
  v_add_f32 v84, v84, v44
  v_add_f32 v86, v86, v45
  v_fmac_f32 v85, v44, v44
  v_fmac_f32 v87, v45, v45
  v_add_f32 v84, v84, v46
  v_add_f32 v86, v86, v47
  v_fmac_f32 v85, v46, v46
  v_fmac_f32 v87, v47, v47
  v_add_f32 v84, v84, v48
  v_add_f32 v86, v86, v49
  v_fmac_f32 v85, v48, v48
  v_fmac_f32 v87, v49, v49
  v_add_f32 v84, v84, v50
  v_add_f32 v86, v86, v51
  v_fmac_f32 v85, v50, v50
  v_fmac_f32 v87, v51, v51
  v_add_f32 v84, v84, v86
  v_add_f32 v85, v85, v87
  s_nop 0
  v_add_f32_dpp v84, v84, v84 row_ror:8 row_mask:0xf bank_mask:0xf
  v_add_f32_dpp v85, v85, v85 row_ror:8 row_mask:0xf bank_mask:0xf
  v_mov_b32 v86, v84
  v_mov_b32 v87, v85
  s_nop 0
  v_permlane16_swap_b32 v84, v86
  v_permlane16_swap_b32 v85, v87
  v_add_f32 v84, v84, v86
  v_add_f32 v85, v85, v87
  v_mov_b32 v86, v84
  v_mov_b32 v87, v85
  s_nop 0
  v_permlane32_swap_b32 v84, v86
  v_permlane32_swap_b32 v85, v87
  v_add_f32 v84, v84, v86
  v_add_f32 v85, v85, v87
  v_cmp_gt_u32 vcc, 8, v2
  s_nop 2
  s_and_saveexec_b64 s[40:41], vcc
  ds_write_b64 v32, v[84:85] offset:0
  s_mov_b64 exec, s[40:41]
  s_waitcnt lgkmcnt(0)
  s_barrier
  ds_read_b64 v[88:89], v15 offset:0
  ds_read_b64 v[90:91], v15 offset:64
  ds_read_b64 v[92:93], v15 offset:128
  ds_read_b64 v[94:95], v15 offset:192
  s_waitcnt lgkmcnt(0)
  v_add_f32 v88, v88, v90
  v_add_f32 v89, v89, v91
  v_add_f32 v92, v92, v94
  v_add_f32 v93, v93, v95
  v_add_f32 v88, v88, v92
  v_add_f32 v89, v89, v93
  v_mul_f32 v84, 0x3b124925, v88
  v_mul_f32 v85, 0x3b124925, v89
  v_fma_f32 v85, -v84, v84, v85
  v_max_f32 v85, 0, v85
  v_add_f32 v85, 0x3727c5ac, v85
  v_rsq_f32 v85, v85
  s_nop 0
  v_mul_f32 v86, v84, v85
  v_fma_f32 v68, v36, v85, -v86
  v_fma_f32 v69, v37, v85, -v86
  v_fma_f32 v70, v38, v85, -v86
  v_fma_f32 v71, v39, v85, -v86
  v_fma_f32 v72, v40, v85, -v86
  v_fma_f32 v73, v41, v85, -v86
  v_fma_f32 v74, v42, v85, -v86
  v_fma_f32 v75, v43, v85, -v86
  v_fma_f32 v76, v44, v85, -v86
  v_fma_f32 v77, v45, v85, -v86
  v_fma_f32 v78, v46, v85, -v86
  v_fma_f32 v79, v47, v85, -v86
  v_fma_f32 v80, v48, v85, -v86
  v_fma_f32 v81, v49, v85, -v86
  v_fma_f32 v82, v50, v85, -v86
  v_fma_f32 v83, v51, v85, -v86
  v_fmac_f32 v36, v68, v52
  v_fmac_f32 v37, v69, v53
  v_fmac_f32 v38, v70, v54
  v_fmac_f32 v39, v71, v55
  v_fmac_f32 v40, v72, v56
  v_fmac_f32 v41, v73, v57
  v_fmac_f32 v42, v74, v58
  v_fmac_f32 v43, v75, v59
  v_fmac_f32 v44, v76, v60
  v_fmac_f32 v45, v77, v61
  v_fmac_f32 v46, v78, v62
  v_fmac_f32 v47, v79, v63
  v_fmac_f32 v48, v80, v64
  v_fmac_f32 v49, v81, v65
  v_fmac_f32 v50, v82, v66
  v_fmac_f32 v51, v83, v67
  v_cvt_pk_bf16_f32 v16, v36, v37
  v_cvt_pk_bf16_f32 v17, v38, v39
  v_cvt_pk_bf16_f32 v18, v40, v41
  v_cvt_pk_bf16_f32 v19, v42, v43
  v_cvt_pk_bf16_f32 v20, v44, v45
  v_cvt_pk_bf16_f32 v21, v46, v47
  v_cvt_pk_bf16_f32 v22, v48, v49
  v_cvt_pk_bf16_f32 v23, v50, v51
  v_lshlrev_b32 v36, 16, v16
  v_and_b32 v37, 0xffff0000, v16
  v_lshlrev_b32 v38, 16, v17
  v_and_b32 v39, 0xffff0000, v17
  v_lshlrev_b32 v40, 16, v18
  v_and_b32 v41, 0xffff0000, v18
  v_lshlrev_b32 v42, 16, v19
  v_and_b32 v43, 0xffff0000, v19
  v_lshlrev_b32 v44, 16, v20
  v_and_b32 v45, 0xffff0000, v20
  v_lshlrev_b32 v46, 16, v21
  v_and_b32 v47, 0xffff0000, v21
  v_lshlrev_b32 v48, 16, v22
  v_and_b32 v49, 0xffff0000, v22
  v_lshlrev_b32 v50, 16, v23
  v_and_b32 v51, 0xffff0000, v23
  buffer_store_dwordx4 v[16:19], v6, s[20:23], 0 offen sc1
  buffer_store_dwordx4 v[20:23], v7, s[20:23], 0 offen sc1
  v_add_f32 v84, v36, v37
  v_mul_f32 v85, v36, v36
  v_add_f32 v86, v38, v39
  v_mul_f32 v87, v37, v37
  v_fmac_f32 v85, v38, v38
  v_fmac_f32 v87, v39, v39
  v_add_f32 v84, v84, v40
  v_add_f32 v86, v86, v41
  v_fmac_f32 v85, v40, v40
  v_fmac_f32 v87, v41, v41
  v_add_f32 v84, v84, v42
  v_add_f32 v86, v86, v43
  v_fmac_f32 v85, v42, v42
  v_fmac_f32 v87, v43, v43
  v_add_f32 v84, v84, v44
  v_add_f32 v86, v86, v45
  v_fmac_f32 v85, v44, v44
  v_fmac_f32 v87, v45, v45
  v_add_f32 v84, v84, v46
  v_add_f32 v86, v86, v47
  v_fmac_f32 v85, v46, v46
  v_fmac_f32 v87, v47, v47
  v_add_f32 v84, v84, v48
  v_add_f32 v86, v86, v49
  v_fmac_f32 v85, v48, v48
  v_fmac_f32 v87, v49, v49
  v_add_f32 v84, v84, v50
  v_add_f32 v86, v86, v51
  v_fmac_f32 v85, v50, v50
  v_fmac_f32 v87, v51, v51
  v_add_f32 v84, v84, v86
  v_add_f32 v85, v85, v87
  s_nop 0
  v_add_f32_dpp v84, v84, v84 row_ror:8 row_mask:0xf bank_mask:0xf
  v_add_f32_dpp v85, v85, v85 row_ror:8 row_mask:0xf bank_mask:0xf
  v_mov_b32 v86, v84
  v_mov_b32 v87, v85
  s_nop 0
  v_permlane16_swap_b32 v84, v86
  v_permlane16_swap_b32 v85, v87
  v_add_f32 v84, v84, v86
  v_add_f32 v85, v85, v87
  v_mov_b32 v86, v84
  v_mov_b32 v87, v85
  s_nop 0
  v_permlane32_swap_b32 v84, v86
  v_permlane32_swap_b32 v85, v87
  v_add_f32 v84, v84, v86
  v_add_f32 v85, v85, v87
  v_cmp_gt_u32 vcc, 8, v2
  s_nop 2
  s_and_saveexec_b64 s[40:41], vcc
  ds_write_b64 v32, v[84:85] offset:256
  s_mov_b64 exec, s[40:41]
  s_waitcnt lgkmcnt(0)
  s_barrier
  ds_read_b64 v[88:89], v15 offset:256
  ds_read_b64 v[90:91], v15 offset:320
  ds_read_b64 v[92:93], v15 offset:384
  ds_read_b64 v[94:95], v15 offset:448
  s_waitcnt lgkmcnt(0)
  v_add_f32 v88, v88, v90
  v_add_f32 v89, v89, v91
  v_add_f32 v92, v92, v94
  v_add_f32 v93, v93, v95
  v_add_f32 v88, v88, v92
  v_add_f32 v89, v89, v93
  v_mul_f32 v84, 0x3b124925, v88
  v_mul_f32 v85, 0x3b124925, v89
  v_fma_f32 v85, -v84, v84, v85
  v_max_f32 v85, 0, v85
  v_add_f32 v85, 0x3727c5ac, v85
  v_rsq_f32 v85, v85
  s_nop 0
  v_mul_f32 v86, v84, v85
  v_fma_f32 v68, v36, v85, -v86
  v_fma_f32 v69, v37, v85, -v86
  v_fma_f32 v70, v38, v85, -v86
  v_fma_f32 v71, v39, v85, -v86
  v_fma_f32 v72, v40, v85, -v86
  v_fma_f32 v73, v41, v85, -v86
  v_fma_f32 v74, v42, v85, -v86
  v_fma_f32 v75, v43, v85, -v86
  v_fma_f32 v76, v44, v85, -v86
  v_fma_f32 v77, v45, v85, -v86
  v_fma_f32 v78, v46, v85, -v86
  v_fma_f32 v79, v47, v85, -v86
  v_fma_f32 v80, v48, v85, -v86
  v_fma_f32 v81, v49, v85, -v86
  v_fma_f32 v82, v50, v85, -v86
  v_fma_f32 v83, v51, v85, -v86
  v_cvt_pk_bf16_f32 v52, v68, v69
  v_cvt_pk_bf16_f32 v53, v70, v71
  v_cvt_pk_bf16_f32 v54, v72, v73
  v_cvt_pk_bf16_f32 v55, v74, v75
  v_cvt_pk_bf16_f32 v56, v76, v77
  v_cvt_pk_bf16_f32 v57, v78, v79
  v_cvt_pk_bf16_f32 v58, v80, v81
  v_cvt_pk_bf16_f32 v59, v82, v83
  buffer_store_dwordx4 v[52:55], v6, s[16:19], 0 offen sc1
  buffer_store_dwordx4 v[56:59], v7, s[16:19], 0 offen sc1
  s_lshr_b32 s59, s2, 2
  s_add_u32 s59, s59, 224
  s_waitcnt vmcnt(0)
  s_waitcnt lgkmcnt(0)
  s_barrier
  s_cmp_lg_u32 s3, 0
  s_cbranch_scc1 L_sig_105
  v_lshlrev_b32 v250, 7, v2
  s_lshl_b32 s60, s59, 7
  v_add_u32 v250, s60, v250
  v_mov_b32 v251, 1
  s_mov_b64 exec, 1
  buffer_atomic_add v251, v250, s[92:95], 0 offen sc1
  s_mov_b64 exec, -1
L_sig_105:
  s_cmp_ge_u32 s91, 28
  s_cbranch_scc1 L_gskip_106
  s_lshl_b32 s59, s53, 2
  s_add_u32 s59, s59, 224
  s_cmp_lg_u32 s3, 0
  s_cbranch_scc1 L_wt_107
  v_lshlrev_b32 v250, 7, v2
  s_lshl_b32 s60, s59, 7
  v_add_u32 v250, s60, v250
  s_mov_b64 exec, 3
  s_mov_b32 s61, 0
L_pl_108:
  buffer_load_dword v251, v250, s[92:95], 0 offen sc1
  s_add_u32 s61, s61, 1
  s_waitcnt vmcnt(0)
  v_cmp_le_u32 vcc, 4, v251
  s_nop 2
  s_cmp_eq_u64 vcc, exec
  s_cbranch_scc1 L_pd_109
  s_sleep 6
  s_cmp_lt_u32 s61, 400000
  s_cbranch_scc1 L_pl_108
L_pd_109:
  s_mov_b64 exec, -1
L_wt_107:
  s_barrier
  s_add_u32 s16, s88, 0xe00000
  s_addc_u32 s17, s89, 0
  s_mov_b32 s18, 0x1c0000
  s_mov_b32 s19, 0x20000
  s_lshl_b32 s32, s53, 2
  s_mul_i32 s34, s32, 28672
  s_mul_i32 s36, s3, 7168
  s_add_u32 s34, s34, s36
  s_add_u32 s37, s34, 0
  buffer_load_dwordx4 v[112:115], v3, s[16:19], s37 offen offset:0 sc1
  buffer_load_dwordx4 v[116:119], v3, s[16:19], s37 offen offset:1024 sc1
  buffer_load_dwordx4 v[120:123], v3, s[16:19], s37 offen offset:2048 sc1
  buffer_load_dwordx4 v[124:127], v3, s[16:19], s37 offen offset:3072 sc1
  s_add_u32 s37, s34, 4096
  buffer_load_dwordx4 v[128:131], v3, s[16:19], s37 offen offset:0 sc1
  buffer_load_dwordx4 v[132:135], v3, s[16:19], s37 offen offset:1024 sc1
  buffer_load_dwordx4 v[136:139], v3, s[16:19], s37 offen offset:2048 sc1
  s_add_u32 s24, s88, 0x1e00000
  s_addc_u32 s25, s89, 0
  s_mov_b32 s26, 0x700000
  s_mov_b32 s27, 0x20000
  v_add_u32 v4, s36, v3
  s_lshl_b32 s31, s54, 2
  s_add_u32 s31, s31, s3
  s_lshl_b32 s40, s31, 11
  s_add_u32 s21, s32, 226
  s_add_u32 s33, s32, 288
  s_lshr_b32 s12, s55, 1
  s_and_b32 s13, s55, 1
  s_lshl_b32 s14, s12, 2
  s_add_u32 s42, s14, s13
  s_sub_u32 s43, 3, s13
  s_add_u32 s43, s43, s14
  s_add_u32 s56, s42, 288
  s_add_u32 s57, s43, 288
  s_mul_i32 s12, s3, 28*1024
  s_mul_i32 s22, s42, 112*1024
  s_add_u32 s22, s22, s12
  s_mul_i32 s23, s43, 112*1024
  s_add_u32 s23, s23, s12
  s_mul_i32 s12, s3, 26624
  s_add_u32 s12, s12, 57344
  v_add_u32 v6, s12, v3
  s_waitcnt vmcnt(0)
  ds_write_b128 v4, v[112:115] offset:0
  ds_write_b128 v4, v[116:119] offset:1024
  ds_write_b128 v4, v[120:123] offset:2048
  ds_write_b128 v4, v[124:127] offset:3072
  ds_write_b128 v4, v[128:131] offset:4096
  ds_write_b128 v4, v[132:135] offset:5120
  ds_write_b128 v4, v[136:139] offset:6144
  s_waitcnt lgkmcnt(0)
  s_barrier
  ds_read_b128 v[80:83], v3 offset:0
  ds_read_b128 v[84:87], v3 offset:1024
  ds_read_b128 v[88:91], v3 offset:2048
  s_waitcnt lgkmcnt(2)
  v_mfma_f32_32x32x16_bf16 v[16:31], a[0:3], v[80:83], 0
  ds_read_b128 v[92:95], v3 offset:3072
  v_mfma_f32_32x32x16_bf16 v[32:47], a[4:7], v[80:83], 0
  s_add_u32 s37, s34, 28672
  buffer_load_dwordx4 v[140:143], v3, s[16:19], s37 offen offset:0 sc1
  s_waitcnt lgkmcnt(2)
  v_mfma_f32_32x32x16_bf16 v[16:31], a[8:11], v[84:87], v[16:31]
  ds_read_b128 v[80:83], v3 offset:4096
  v_mfma_f32_32x32x16_bf16 v[32:47], a[12:15], v[84:87], v[32:47]
  buffer_load_dwordx4 v[144:147], v3, s[16:19], s37 offen offset:1024 sc1
  s_waitcnt lgkmcnt(2)
  v_mfma_f32_32x32x16_bf16 v[16:31], a[16:19], v[88:91], v[16:31]
  ds_read_b128 v[84:87], v3 offset:5120
  v_mfma_f32_32x32x16_bf16 v[32:47], a[20:23], v[88:91], v[32:47]
  buffer_load_dwordx4 v[148:151], v3, s[16:19], s37 offen offset:2048 sc1
  s_waitcnt lgkmcnt(2)
  v_mfma_f32_32x32x16_bf16 v[16:31], a[24:27], v[92:95], v[16:31]
  ds_read_b128 v[88:91], v3 offset:6144
  v_mfma_f32_32x32x16_bf16 v[32:47], a[28:31], v[92:95], v[32:47]
  buffer_load_dwordx4 v[152:155], v3, s[16:19], s37 offen offset:3072 sc1
  s_waitcnt lgkmcnt(2)
  v_mfma_f32_32x32x16_bf16 v[16:31], a[32:35], v[80:83], v[16:31]
  ds_read_b128 v[92:95], v3 offset:7168
  v_mfma_f32_32x32x16_bf16 v[32:47], a[36:39], v[80:83], v[32:47]
  s_add_u32 s37, s34, 32768
  buffer_load_dwordx4 v[156:159], v3, s[16:19], s37 offen offset:0 sc1
  s_waitcnt lgkmcnt(2)
  v_mfma_f32_32x32x16_bf16 v[16:31], a[40:43], v[84:87], v[16:31]
  ds_read_b128 v[80:83], v3 offset:8192
  v_mfma_f32_32x32x16_bf16 v[32:47], a[44:47], v[84:87], v[32:47]
  buffer_load_dwordx4 v[160:163], v3, s[16:19], s37 offen offset:1024 sc1
  s_waitcnt lgkmcnt(2)
  v_mfma_f32_32x32x16_bf16 v[16:31], a[48:51], v[88:91], v[16:31]
  ds_read_b128 v[84:87], v3 offset:9216
  v_mfma_f32_32x32x16_bf16 v[32:47], a[52:55], v[88:91], v[32:47]
  buffer_load_dwordx4 v[164:167], v3, s[16:19], s37 offen offset:2048 sc1
  s_waitcnt lgkmcnt(2)
  v_mfma_f32_32x32x16_bf16 v[16:31], a[56:59], v[92:95], v[16:31]
  ds_read_b128 v[88:91], v3 offset:10240
  v_mfma_f32_32x32x16_bf16 v[32:47], a[60:63], v[92:95], v[32:47]
  s_waitcnt lgkmcnt(2)
  v_mfma_f32_32x32x16_bf16 v[16:31], a[64:67], v[80:83], v[16:31]
  ds_read_b128 v[92:95], v3 offset:11264
  v_mfma_f32_32x32x16_bf16 v[32:47], a[68:71], v[80:83], v[32:47]
  s_waitcnt lgkmcnt(2)
  v_mfma_f32_32x32x16_bf16 v[16:31], a[72:75], v[84:87], v[16:31]
  ds_read_b128 v[80:83], v3 offset:12288
  v_mfma_f32_32x32x16_bf16 v[32:47], a[76:79], v[84:87], v[32:47]
  s_waitcnt lgkmcnt(2)
  v_mfma_f32_32x32x16_bf16 v[16:31], a[80:83], v[88:91], v[16:31]
  ds_read_b128 v[84:87], v3 offset:13312
  v_mfma_f32_32x32x16_bf16 v[32:47], a[84:87], v[88:91], v[32:47]
  s_waitcnt lgkmcnt(2)
  v_mfma_f32_32x32x16_bf16 v[16:31], a[88:91], v[92:95], v[16:31]
  ds_read_b128 v[88:91], v3 offset:14336
  v_mfma_f32_32x32x16_bf16 v[32:47], a[92:95], v[92:95], v[32:47]
  s_waitcnt vmcnt(0)
  ds_write_b128 v4, v[140:143] offset:28672
  s_waitcnt lgkmcnt(3)
  v_mfma_f32_32x32x16_bf16 v[16:31], a[96:99], v[80:83], v[16:31]
  ds_read_b128 v[92:95], v3 offset:15360
  v_mfma_f32_32x32x16_bf16 v[32:47], a[100:103], v[80:83], v[32:47]
  ds_write_b128 v4, v[144:147] offset:29696
  s_cmp_lg_u32 s3, 0
  s_cbranch_scc1 L_pi_110
  v_lshlrev_b32 v252, 7, v2
  s_lshl_b32 s60, s21, 7
  v_add_u32 v252, s60, v252
  s_mov_b64 exec, 3
  buffer_load_dword v253, v252, s[92:95], 0 offen sc1
  s_mov_b64 exec, -1
L_pi_110:
  s_waitcnt lgkmcnt(4)
  v_mfma_f32_32x32x16_bf16 v[16:31], a[104:107], v[84:87], v[16:31]
  ds_read_b128 v[80:83], v3 offset:16384
  v_mfma_f32_32x32x16_bf16 v[32:47], a[108:111], v[84:87], v[32:47]
  ds_write_b128 v4, v[148:151] offset:30720
  s_waitcnt lgkmcnt(5)
  v_mfma_f32_32x32x16_bf16 v[16:31], a[112:115], v[88:91], v[16:31]
  ds_read_b128 v[84:87], v3 offset:17408
  v_mfma_f32_32x32x16_bf16 v[32:47], a[116:119], v[88:91], v[32:47]
  ds_write_b128 v4, v[152:155] offset:31744
  s_waitcnt lgkmcnt(5)
  v_mfma_f32_32x32x16_bf16 v[16:31], a[120:123], v[92:95], v[16:31]
  ds_read_b128 v[88:91], v3 offset:18432
  v_mfma_f32_32x32x16_bf16 v[32:47], a[124:127], v[92:95], v[32:47]
  ds_write_b128 v4, v[156:159] offset:32768
  s_waitcnt lgkmcnt(5)
  v_mfma_f32_32x32x16_bf16 v[16:31], a[128:131], v[80:83], v[16:31]
  ds_read_b128 v[92:95], v3 offset:19456
  v_mfma_f32_32x32x16_bf16 v[32:47], a[132:135], v[80:83], v[32:47]
  ds_write_b128 v4, v[160:163] offset:33792
  s_waitcnt lgkmcnt(5)
  v_mfma_f32_32x32x16_bf16 v[16:31], a[136:139], v[84:87], v[16:31]
  ds_read_b128 v[80:83], v3 offset:20480
  v_mfma_f32_32x32x16_bf16 v[32:47], a[140:143], v[84:87], v[32:47]
  ds_write_b128 v4, v[164:167] offset:34816
  s_waitcnt lgkmcnt(5)
  v_mfma_f32_32x32x16_bf16 v[16:31], a[144:147], v[88:91], v[16:31]
  ds_read_b128 v[84:87], v3 offset:21504
  v_mfma_f32_32x32x16_bf16 v[32:47], a[148:151], v[88:91], v[32:47]
  s_waitcnt lgkmcnt(4)
  v_mfma_f32_32x32x16_bf16 v[16:31], a[152:155], v[92:95], v[16:31]
  ds_read_b128 v[88:91], v3 offset:22528
  v_mfma_f32_32x32x16_bf16 v[32:47], a[156:159], v[92:95], v[32:47]
  s_waitcnt lgkmcnt(2)
  s_barrier
  v_mfma_f32_32x32x16_bf16 v[16:31], a[160:163], v[80:83], v[16:31]
  ds_read_b128 v[92:95], v3 offset:23552
  v_mfma_f32_32x32x16_bf16 v[32:47], a[164:167], v[80:83], v[32:47]
  s_cmp_lg_u32 s3, 0
  s_cbranch_scc1 L_pc_111
  s_waitcnt vmcnt(0)
  s_mov_b64 exec, 3
  v_cmp_le_u32 vcc, 4, v253
  s_nop 2
  s_cmp_eq_u64 vcc, exec
  s_mov_b64 exec, -1
  s_cbranch_scc1 L_pc_111
  s_cmp_lg_u32 s3, 0
  s_cbranch_scc1 L_wt_112
  v_lshlrev_b32 v250, 7, v2
  s_lshl_b32 s60, s21, 7
  v_add_u32 v250, s60, v250
  s_mov_b64 exec, 3
  s_mov_b32 s61, 0
L_pl_113:
  buffer_load_dword v251, v250, s[92:95], 0 offen sc1
  s_add_u32 s61, s61, 1
  s_waitcnt vmcnt(0)
  v_cmp_le_u32 vcc, 4, v251
  s_nop 2
  s_cmp_eq_u64 vcc, exec
  s_cbranch_scc1 L_pd_114
  s_sleep 6
  s_cmp_lt_u32 s61, 400000
  s_cbranch_scc1 L_pl_113
L_pd_114:
  s_mov_b64 exec, -1
L_wt_112:
L_pc_111:
  s_barrier
  s_waitcnt lgkmcnt(2)
  v_mfma_f32_32x32x16_bf16 v[16:31], a[168:171], v[84:87], v[16:31]
  ds_read_b128 v[80:83], v3 offset:24576
  v_mfma_f32_32x32x16_bf16 v[32:47], a[172:175], v[84:87], v[32:47]
  s_add_u32 s37, s34, 57344
  buffer_load_dwordx4 v[112:115], v3, s[16:19], s37 offen offset:0 sc1
  s_waitcnt lgkmcnt(2)
  v_mfma_f32_32x32x16_bf16 v[16:31], a[176:179], v[88:91], v[16:31]
  ds_read_b128 v[84:87], v3 offset:25600
  v_mfma_f32_32x32x16_bf16 v[32:47], a[180:183], v[88:91], v[32:47]
  buffer_load_dwordx4 v[116:119], v3, s[16:19], s37 offen offset:1024 sc1
  s_waitcnt lgkmcnt(2)
  v_mfma_f32_32x32x16_bf16 v[16:31], a[184:187], v[92:95], v[16:31]
  ds_read_b128 v[88:91], v3 offset:26624
  v_mfma_f32_32x32x16_bf16 v[32:47], a[188:191], v[92:95], v[32:47]
  buffer_load_dwordx4 v[120:123], v3, s[16:19], s37 offen offset:2048 sc1
  s_waitcnt lgkmcnt(2)
  v_mfma_f32_32x32x16_bf16 v[16:31], a[192:195], v[80:83], v[16:31]
  ds_read_b128 v[92:95], v3 offset:27648
  v_mfma_f32_32x32x16_bf16 v[32:47], a[196:199], v[80:83], v[32:47]
  buffer_load_dwordx4 v[124:127], v3, s[16:19], s37 offen offset:3072 sc1
  s_waitcnt lgkmcnt(2)
  v_mfma_f32_32x32x16_bf16 v[16:31], a[200:203], v[84:87], v[16:31]
  ds_read_b128 v[80:83], v3 offset:28672
  v_mfma_f32_32x32x16_bf16 v[32:47], a[204:207], v[84:87], v[32:47]
  s_add_u32 s37, s34, 61440
  buffer_load_dwordx4 v[128:131], v3, s[16:19], s37 offen offset:0 sc1
  s_waitcnt lgkmcnt(2)
  v_mfma_f32_32x32x16_bf16 v[16:31], a[208:211], v[88:91], v[16:31]
  ds_read_b128 v[84:87], v3 offset:29696
  v_mfma_f32_32x32x16_bf16 v[32:47], a[212:215], v[88:91], v[32:47]
  buffer_load_dwordx4 v[132:135], v3, s[16:19], s37 offen offset:1024 sc1
  s_waitcnt lgkmcnt(2)
  v_mfma_f32_32x32x16_bf16 v[16:31], a[216:219], v[92:95], v[16:31]
  ds_read_b128 v[88:91], v3 offset:30720
  v_mfma_f32_32x32x16_bf16 v[32:47], a[220:223], v[92:95], v[32:47]
  buffer_load_dwordx4 v[136:139], v3, s[16:19], s37 offen offset:2048 sc1
  s_waitcnt lgkmcnt(2)
  v_mfma_f32_32x32x16_bf16 v[48:63], a[0:3], v[80:83], 0
  ds_read_b128 v[92:95], v3 offset:31744
  v_mfma_f32_32x32x16_bf16 v[64:79], a[4:7], v[80:83], 0
  s_add_u32 s37, s34, 86016
  buffer_load_dwordx4 v[140:143], v3, s[16:19], s37 offen offset:0 sc1
  s_waitcnt lgkmcnt(2)
  v_mfma_f32_32x32x16_bf16 v[48:63], a[8:11], v[84:87], v[48:63]
  ds_read_b128 v[80:83], v3 offset:32768
  s_add_u32 s41, s32, 0
  s_mul_i32 s41, s41, 112*1024
  s_add_u32 s41, s41, s40
  v_mul_f32 v96, 0xbfb8aa3b, v16
  v_mul_f32 v97, 0xbfb8aa3b, v17
  v_mfma_f32_32x32x16_bf16 v[64:79], a[12:15], v[84:87], v[64:79]
  v_mul_f32 v98, 0xbfb8aa3b, v18
  v_mul_f32 v99, 0xbfb8aa3b, v19
  buffer_load_dwordx4 v[144:147], v3, s[16:19], s37 offen offset:1024 sc1
  s_waitcnt lgkmcnt(2)
  v_mfma_f32_32x32x16_bf16 v[48:63], a[16:19], v[88:91], v[48:63]
  ds_read_b128 v[84:87], v3 offset:33792
  v_mul_f32 v100, 0xbfb8aa3b, v20
  v_mul_f32 v101, 0xbfb8aa3b, v21
  v_mfma_f32_32x32x16_bf16 v[64:79], a[20:23], v[88:91], v[64:79]
  v_mul_f32 v102, 0xbfb8aa3b, v22
  v_mul_f32 v103, 0xbfb8aa3b, v23
  buffer_load_dwordx4 v[148:151], v3, s[16:19], s37 offen offset:2048 sc1
  s_waitcnt lgkmcnt(2)
  v_mfma_f32_32x32x16_bf16 v[48:63], a[24:27], v[92:95], v[48:63]
  ds_read_b128 v[88:91], v3 offset:34816
  v_exp_f32 v96, v96
  v_exp_f32 v97, v97
  v_exp_f32 v98, v98
  v_mfma_f32_32x32x16_bf16 v[64:79], a[28:31], v[92:95], v[64:79]
  v_exp_f32 v99, v99
  v_exp_f32 v100, v100
  buffer_load_dwordx4 v[152:155], v3, s[16:19], s37 offen offset:3072 sc1
  s_waitcnt lgkmcnt(2)
  v_mfma_f32_32x32x16_bf16 v[48:63], a[32:35], v[80:83], v[48:63]
  ds_read_b128 v[92:95], v3 offset:35840
  v_exp_f32 v101, v101
  v_exp_f32 v102, v102
  v_mfma_f32_32x32x16_bf16 v[64:79], a[36:39], v[80:83], v[64:79]
  v_exp_f32 v103, v103
  v_mul_f32 v32, v16, v32
  s_add_u32 s37, s34, 90112
  buffer_load_dwordx4 v[156:159], v3, s[16:19], s37 offen offset:0 sc1
  s_waitcnt lgkmcnt(2)
  v_mfma_f32_32x32x16_bf16 v[48:63], a[40:43], v[84:87], v[48:63]
  ds_read_b128 v[80:83], v3 offset:36864
  v_mul_f32 v33, v17, v33
  v_mul_f32 v34, v18, v34
  v_mfma_f32_32x32x16_bf16 v[64:79], a[44:47], v[84:87], v[64:79]
  v_mul_f32 v35, v19, v35
  v_mul_f32 v36, v20, v36
  buffer_load_dwordx4 v[160:163], v3, s[16:19], s37 offen offset:1024 sc1
  s_waitcnt lgkmcnt(2)
  v_mfma_f32_32x32x16_bf16 v[48:63], a[48:51], v[88:91], v[48:63]
  ds_read_b128 v[84:87], v3 offset:37888
  v_mul_f32 v37, v21, v37
  v_mul_f32 v38, v22, v38
  v_mul_f32 v39, v23, v39
  v_mfma_f32_32x32x16_bf16 v[64:79], a[52:55], v[88:91], v[64:79]
  v_add_f32 v96, 1.0, v96
  v_add_f32 v97, 1.0, v97
  buffer_load_dwordx4 v[164:167], v3, s[16:19], s37 offen offset:2048 sc1
  s_waitcnt lgkmcnt(2)
  v_mfma_f32_32x32x16_bf16 v[48:63], a[56:59], v[92:95], v[48:63]
  ds_read_b128 v[88:91], v3 offset:38912
  v_add_f32 v98, 1.0, v98
  v_add_f32 v99, 1.0, v99
  v_mfma_f32_32x32x16_bf16 v[64:79], a[60:63], v[92:95], v[64:79]
  v_add_f32 v100, 1.0, v100
  v_add_f32 v101, 1.0, v101
  s_barrier
  s_waitcnt lgkmcnt(2)
  v_mfma_f32_32x32x16_bf16 v[48:63], a[64:67], v[80:83], v[48:63]
  ds_read_b128 v[92:95], v3 offset:39936
  v_add_f32 v102, 1.0, v102
  v_add_f32 v103, 1.0, v103
  v_mfma_f32_32x32x16_bf16 v[64:79], a[68:71], v[80:83], v[64:79]
  v_rcp_f32 v96, v96
  v_rcp_f32 v97, v97
  v_rcp_f32 v98, v98
  s_waitcnt vmcnt(7)
  ds_write_b128 v4, v[112:115] offset:0
  s_waitcnt lgkmcnt(3)
  v_mfma_f32_32x32x16_bf16 v[48:63], a[72:75], v[84:87], v[48:63]
  ds_read_b128 v[80:83], v3 offset:40960
  v_rcp_f32 v99, v99
  v_rcp_f32 v100, v100
  v_mfma_f32_32x32x16_bf16 v[64:79], a[76:79], v[84:87], v[64:79]
  v_rcp_f32 v101, v101
  v_rcp_f32 v102, v102
  ds_write_b128 v4, v[116:119] offset:1024
  s_waitcnt lgkmcnt(4)
  v_mfma_f32_32x32x16_bf16 v[48:63], a[80:83], v[88:91], v[48:63]
  ds_read_b128 v[84:87], v3 offset:41984
  v_rcp_f32 v103, v103
  v_mul_f32 v32, v32, v96
  v_mfma_f32_32x32x16_bf16 v[64:79], a[84:87], v[88:91], v[64:79]
  v_mul_f32 v33, v33, v97
  v_mul_f32 v34, v34, v98
  ds_write_b128 v4, v[120:123] offset:2048
  s_waitcnt lgkmcnt(5)
  v_mfma_f32_32x32x16_bf16 v[48:63], a[88:91], v[92:95], v[48:63]
  ds_read_b128 v[88:91], v3 offset:43008
  v_mul_f32 v35, v35, v99
  v_mul_f32 v36, v36, v100
  v_mfma_f32_32x32x16_bf16 v[64:79], a[92:95], v[92:95], v[64:79]
  v_mul_f32 v37, v37, v101
  v_mul_f32 v38, v38, v102
  v_mul_f32 v39, v39, v103
  ds_write_b128 v4, v[124:127] offset:3072
  s_waitcnt lgkmcnt(5)
  v_mfma_f32_32x32x16_bf16 v[48:63], a[96:99], v[80:83], v[48:63]
  ds_read_b128 v[92:95], v3 offset:44032
  v_cvt_pk_bf16_f32 v16, v32, v33
  v_cvt_pk_bf16_f32 v17, v34, v35
  v_mfma_f32_32x32x16_bf16 v[64:79], a[100:103], v[80:83], v[64:79]
  v_cvt_pk_bf16_f32 v18, v36, v37
  v_cvt_pk_bf16_f32 v19, v38, v39
  ds_write_b128 v4, v[128:131] offset:4096
  s_waitcnt lgkmcnt(5)
  v_mfma_f32_32x32x16_bf16 v[48:63], a[104:107], v[84:87], v[48:63]
  ds_read_b128 v[80:83], v3 offset:45056
  buffer_store_dwordx4 v[16:19], v3, s[24:27], s41 offen offset:0 sc1
  v_mul_f32 v96, 0xbfb8aa3b, v24
  v_mfma_f32_32x32x16_bf16 v[64:79], a[108:111], v[84:87], v[64:79]
  v_mul_f32 v97, 0xbfb8aa3b, v25
  v_mul_f32 v98, 0xbfb8aa3b, v26
  ds_write_b128 v4, v[132:135] offset:5120
  s_waitcnt lgkmcnt(5)
  v_mfma_f32_32x32x16_bf16 v[48:63], a[112:115], v[88:91], v[48:63]
  ds_read_b128 v[84:87], v3 offset:46080
  v_mul_f32 v99, 0xbfb8aa3b, v27
  v_mul_f32 v100, 0xbfb8aa3b, v28
  v_mul_f32 v101, 0xbfb8aa3b, v29
  v_mfma_f32_32x32x16_bf16 v[64:79], a[116:119], v[88:91], v[64:79]
  v_mul_f32 v102, 0xbfb8aa3b, v30
  v_mul_f32 v103, 0xbfb8aa3b, v31
  ds_write_b128 v4, v[136:139] offset:6144
  s_waitcnt lgkmcnt(5)
  v_mfma_f32_32x32x16_bf16 v[48:63], a[120:123], v[92:95], v[48:63]
  ds_read_b128 v[88:91], v3 offset:47104
  v_exp_f32 v96, v96
  v_exp_f32 v97, v97
  v_mfma_f32_32x32x16_bf16 v[64:79], a[124:127], v[92:95], v[64:79]
  v_exp_f32 v98, v98
  v_exp_f32 v99, v99
  s_waitcnt lgkmcnt(4)
  v_mfma_f32_32x32x16_bf16 v[48:63], a[128:131], v[80:83], v[48:63]
  ds_read_b128 v[92:95], v3 offset:48128
  v_exp_f32 v100, v100
  v_exp_f32 v101, v101
  v_mfma_f32_32x32x16_bf16 v[64:79], a[132:135], v[80:83], v[64:79]
  v_exp_f32 v102, v102
  v_exp_f32 v103, v103
  s_waitcnt lgkmcnt(2)
  s_barrier
  v_mfma_f32_32x32x16_bf16 v[48:63], a[136:139], v[84:87], v[48:63]
  ds_read_b128 v[80:83], v3 offset:49152
  v_mul_f32 v40, v24, v40
  v_mul_f32 v41, v25, v41
  v_mul_f32 v42, v26, v42
  v_mfma_f32_32x32x16_bf16 v[64:79], a[140:143], v[84:87], v[64:79]
  v_mul_f32 v43, v27, v43
  v_mul_f32 v44, v28, v44
  s_waitcnt lgkmcnt(2)
  v_mfma_f32_32x32x16_bf16 v[48:63], a[144:147], v[88:91], v[48:63]
  ds_read_b128 v[84:87], v3 offset:50176
  v_mul_f32 v45, v29, v45
  v_mul_f32 v46, v30, v46
  v_mfma_f32_32x32x16_bf16 v[64:79], a[148:151], v[88:91], v[64:79]
  v_mul_f32 v47, v31, v47
  v_add_f32 v96, 1.0, v96
  s_waitcnt lgkmcnt(2)
  v_mfma_f32_32x32x16_bf16 v[48:63], a[152:155], v[92:95], v[48:63]
  ds_read_b128 v[88:91], v3 offset:51200
  v_add_f32 v97, 1.0, v97
  v_add_f32 v98, 1.0, v98
  v_mfma_f32_32x32x16_bf16 v[64:79], a[156:159], v[92:95], v[64:79]
  v_add_f32 v99, 1.0, v99
  v_add_f32 v100, 1.0, v100
  v_add_f32 v101, 1.0, v101
  s_waitcnt lgkmcnt(2)
  v_mfma_f32_32x32x16_bf16 v[48:63], a[160:163], v[80:83], v[48:63]
  ds_read_b128 v[92:95], v3 offset:52224
  v_add_f32 v102, 1.0, v102
  v_add_f32 v103, 1.0, v103
  v_mfma_f32_32x32x16_bf16 v[64:79], a[164:167], v[80:83], v[64:79]
  v_rcp_f32 v96, v96
  v_rcp_f32 v97, v97
  s_waitcnt lgkmcnt(2)
  v_mfma_f32_32x32x16_bf16 v[48:63], a[168:171], v[84:87], v[48:63]
  ds_read_b128 v[80:83], v3 offset:53248
  v_rcp_f32 v98, v98
  v_rcp_f32 v99, v99
  v_mfma_f32_32x32x16_bf16 v[64:79], a[172:175], v[84:87], v[64:79]
  v_rcp_f32 v100, v100
  v_rcp_f32 v101, v101
  s_waitcnt lgkmcnt(2)
  v_mfma_f32_32x32x16_bf16 v[48:63], a[176:179], v[88:91], v[48:63]
  ds_read_b128 v[84:87], v3 offset:54272
  v_rcp_f32 v102, v102
  v_rcp_f32 v103, v103
  v_mfma_f32_32x32x16_bf16 v[64:79], a[180:183], v[88:91], v[64:79]
  v_mul_f32 v40, v40, v96
  v_mul_f32 v41, v41, v97
  v_mul_f32 v42, v42, v98
  s_waitcnt lgkmcnt(2)
  v_mfma_f32_32x32x16_bf16 v[48:63], a[184:187], v[92:95], v[48:63]
  ds_read_b128 v[88:91], v3 offset:55296
  v_mul_f32 v43, v43, v99
  v_mul_f32 v44, v44, v100
  v_mfma_f32_32x32x16_bf16 v[64:79], a[188:191], v[92:95], v[64:79]
  v_mul_f32 v45, v45, v101
  v_mul_f32 v46, v46, v102
  s_waitcnt lgkmcnt(2)
  v_mfma_f32_32x32x16_bf16 v[48:63], a[192:195], v[80:83], v[48:63]
  ds_read_b128 v[92:95], v3 offset:56320
  v_mul_f32 v47, v47, v103
  v_cvt_pk_bf16_f32 v24, v40, v41
  v_mfma_f32_32x32x16_bf16 v[64:79], a[196:199], v[80:83], v[64:79]
  v_cvt_pk_bf16_f32 v25, v42, v43
  v_cvt_pk_bf16_f32 v26, v44, v45
  s_waitcnt lgkmcnt(2)
  v_mfma_f32_32x32x16_bf16 v[48:63], a[200:203], v[84:87], v[48:63]
  ds_read_b128 v[80:83], v3 offset:0
  v_cvt_pk_bf16_f32 v27, v46, v47
  buffer_store_dwordx4 v[24:27], v3, s[24:27], s41 offen offset:1024 sc1
  v_mfma_f32_32x32x16_bf16 v[64:79], a[204:207], v[84:87], v[64:79]
  s_waitcnt lgkmcnt(2)
  v_mfma_f32_32x32x16_bf16 v[48:63], a[208:211], v[88:91], v[48:63]
  ds_read_b128 v[84:87], v3 offset:1024
  v_mfma_f32_32x32x16_bf16 v[64:79], a[212:215], v[88:91], v[64:79]
  s_waitcnt lgkmcnt(2)
  v_mfma_f32_32x32x16_bf16 v[48:63], a[216:219], v[92:95], v[48:63]
  ds_read_b128 v[88:91], v3 offset:2048
  v_mfma_f32_32x32x16_bf16 v[64:79], a[220:223], v[92:95], v[64:79]
  s_waitcnt lgkmcnt(2)
  v_mfma_f32_32x32x16_bf16 v[16:31], a[0:3], v[80:83], 0
  ds_read_b128 v[92:95], v3 offset:3072
  v_mfma_f32_32x32x16_bf16 v[32:47], a[4:7], v[80:83], 0
  s_waitcnt lgkmcnt(2)
  v_mfma_f32_32x32x16_bf16 v[16:31], a[8:11], v[84:87], v[16:31]
  ds_read_b128 v[80:83], v3 offset:4096
  s_add_u32 s41, s32, 1
  s_mul_i32 s41, s41, 112*1024
  s_add_u32 s41, s41, s40
  v_mul_f32 v96, 0xbfb8aa3b, v48
  v_mul_f32 v97, 0xbfb8aa3b, v49
  v_mfma_f32_32x32x16_bf16 v[32:47], a[12:15], v[84:87], v[32:47]
  v_mul_f32 v98, 0xbfb8aa3b, v50
  v_mul_f32 v99, 0xbfb8aa3b, v51
  s_waitcnt lgkmcnt(2)
  v_mfma_f32_32x32x16_bf16 v[16:31], a[16:19], v[88:91], v[16:31]
  ds_read_b128 v[84:87], v3 offset:5120
  v_mul_f32 v100, 0xbfb8aa3b, v52
  v_mul_f32 v101, 0xbfb8aa3b, v53
  v_mfma_f32_32x32x16_bf16 v[32:47], a[20:23], v[88:91], v[32:47]
  v_mul_f32 v102, 0xbfb8aa3b, v54
  v_mul_f32 v103, 0xbfb8aa3b, v55
  s_waitcnt lgkmcnt(2)
  v_mfma_f32_32x32x16_bf16 v[16:31], a[24:27], v[92:95], v[16:31]
  ds_read_b128 v[88:91], v3 offset:6144
  v_exp_f32 v96, v96
  v_exp_f32 v97, v97
  v_exp_f32 v98, v98
  v_mfma_f32_32x32x16_bf16 v[32:47], a[28:31], v[92:95], v[32:47]
  v_exp_f32 v99, v99
  v_exp_f32 v100, v100
  s_waitcnt lgkmcnt(2)
  v_mfma_f32_32x32x16_bf16 v[16:31], a[32:35], v[80:83], v[16:31]
  ds_read_b128 v[92:95], v3 offset:7168
  v_exp_f32 v101, v101
  v_exp_f32 v102, v102
  v_mfma_f32_32x32x16_bf16 v[32:47], a[36:39], v[80:83], v[32:47]
  v_exp_f32 v103, v103
  v_mul_f32 v64, v48, v64
  s_waitcnt lgkmcnt(2)
  v_mfma_f32_32x32x16_bf16 v[16:31], a[40:43], v[84:87], v[16:31]
  ds_read_b128 v[80:83], v3 offset:8192
  v_mul_f32 v65, v49, v65
  v_mul_f32 v66, v50, v66
  v_mfma_f32_32x32x16_bf16 v[32:47], a[44:47], v[84:87], v[32:47]
  v_mul_f32 v67, v51, v67
  v_mul_f32 v68, v52, v68
  s_waitcnt lgkmcnt(2)
  v_mfma_f32_32x32x16_bf16 v[16:31], a[48:51], v[88:91], v[16:31]
  ds_read_b128 v[84:87], v3 offset:9216
  v_mul_f32 v69, v53, v69
  v_mul_f32 v70, v54, v70
  v_mul_f32 v71, v55, v71
  v_mfma_f32_32x32x16_bf16 v[32:47], a[52:55], v[88:91], v[32:47]
  v_add_f32 v96, 1.0, v96
  v_add_f32 v97, 1.0, v97
  s_waitcnt lgkmcnt(2)
  v_mfma_f32_32x32x16_bf16 v[16:31], a[56:59], v[92:95], v[16:31]
  ds_read_b128 v[88:91], v3 offset:10240
  v_add_f32 v98, 1.0, v98
  v_add_f32 v99, 1.0, v99
  v_mfma_f32_32x32x16_bf16 v[32:47], a[60:63], v[92:95], v[32:47]
  v_add_f32 v100, 1.0, v100
  v_add_f32 v101, 1.0, v101
  s_barrier
  s_waitcnt lgkmcnt(2)
  v_mfma_f32_32x32x16_bf16 v[16:31], a[64:67], v[80:83], v[16:31]
  ds_read_b128 v[92:95], v3 offset:11264
  v_add_f32 v102, 1.0, v102
  v_add_f32 v103, 1.0, v103
  v_mfma_f32_32x32x16_bf16 v[32:47], a[68:71], v[80:83], v[32:47]
  v_rcp_f32 v96, v96
  v_rcp_f32 v97, v97
  v_rcp_f32 v98, v98
  s_waitcnt vmcnt(2)
  ds_write_b128 v4, v[140:143] offset:28672
  s_waitcnt lgkmcnt(3)
  v_mfma_f32_32x32x16_bf16 v[16:31], a[72:75], v[84:87], v[16:31]
  ds_read_b128 v[80:83], v3 offset:12288
  v_rcp_f32 v99, v99
  v_rcp_f32 v100, v100
  v_mfma_f32_32x32x16_bf16 v[32:47], a[76:79], v[84:87], v[32:47]
  v_rcp_f32 v101, v101
  v_rcp_f32 v102, v102
  ds_write_b128 v4, v[144:147] offset:29696
  s_waitcnt lgkmcnt(4)
  v_mfma_f32_32x32x16_bf16 v[16:31], a[80:83], v[88:91], v[16:31]
  ds_read_b128 v[84:87], v3 offset:13312
  v_rcp_f32 v103, v103
  v_mul_f32 v64, v64, v96
  v_mfma_f32_32x32x16_bf16 v[32:47], a[84:87], v[88:91], v[32:47]
  v_mul_f32 v65, v65, v97
  v_mul_f32 v66, v66, v98
  ds_write_b128 v4, v[148:151] offset:30720
  s_waitcnt lgkmcnt(5)
  v_mfma_f32_32x32x16_bf16 v[16:31], a[88:91], v[92:95], v[16:31]
  ds_read_b128 v[88:91], v3 offset:14336
  v_mul_f32 v67, v67, v99
  v_mul_f32 v68, v68, v100
  v_mfma_f32_32x32x16_bf16 v[32:47], a[92:95], v[92:95], v[32:47]
  v_mul_f32 v69, v69, v101
  v_mul_f32 v70, v70, v102
  v_mul_f32 v71, v71, v103
  ds_write_b128 v4, v[152:155] offset:31744
  s_waitcnt lgkmcnt(5)
  v_mfma_f32_32x32x16_bf16 v[16:31], a[96:99], v[80:83], v[16:31]
  ds_read_b128 v[92:95], v3 offset:15360
  v_cvt_pk_bf16_f32 v48, v64, v65
  v_cvt_pk_bf16_f32 v49, v66, v67
  v_mfma_f32_32x32x16_bf16 v[32:47], a[100:103], v[80:83], v[32:47]
  v_cvt_pk_bf16_f32 v50, v68, v69
  v_cvt_pk_bf16_f32 v51, v70, v71
  ds_write_b128 v4, v[156:159] offset:32768
  s_waitcnt lgkmcnt(5)
  v_mfma_f32_32x32x16_bf16 v[16:31], a[104:107], v[84:87], v[16:31]
  ds_read_b128 v[80:83], v3 offset:16384
  buffer_store_dwordx4 v[48:51], v3, s[24:27], s41 offen offset:0 sc1
  v_mul_f32 v96, 0xbfb8aa3b, v56
  v_mfma_f32_32x32x16_bf16 v[32:47], a[108:111], v[84:87], v[32:47]
  v_mul_f32 v97, 0xbfb8aa3b, v57
  v_mul_f32 v98, 0xbfb8aa3b, v58
  ds_write_b128 v4, v[160:163] offset:33792
  s_waitcnt lgkmcnt(5)
  v_mfma_f32_32x32x16_bf16 v[16:31], a[112:115], v[88:91], v[16:31]
  ds_read_b128 v[84:87], v3 offset:17408
  v_mul_f32 v99, 0xbfb8aa3b, v59
  v_mul_f32 v100, 0xbfb8aa3b, v60
  v_mul_f32 v101, 0xbfb8aa3b, v61
  v_mfma_f32_32x32x16_bf16 v[32:47], a[116:119], v[88:91], v[32:47]
  v_mul_f32 v102, 0xbfb8aa3b, v62
  v_mul_f32 v103, 0xbfb8aa3b, v63
  ds_write_b128 v4, v[164:167] offset:34816
  s_waitcnt lgkmcnt(5)
  v_mfma_f32_32x32x16_bf16 v[16:31], a[120:123], v[92:95], v[16:31]
  ds_read_b128 v[88:91], v3 offset:18432
  v_exp_f32 v96, v96
  v_exp_f32 v97, v97
  v_mfma_f32_32x32x16_bf16 v[32:47], a[124:127], v[92:95], v[32:47]
  v_exp_f32 v98, v98
  v_exp_f32 v99, v99
  s_waitcnt lgkmcnt(4)
  v_mfma_f32_32x32x16_bf16 v[16:31], a[128:131], v[80:83], v[16:31]
  ds_read_b128 v[92:95], v3 offset:19456
  v_exp_f32 v100, v100
  v_exp_f32 v101, v101
  v_mfma_f32_32x32x16_bf16 v[32:47], a[132:135], v[80:83], v[32:47]
  v_exp_f32 v102, v102
  v_exp_f32 v103, v103
  s_waitcnt lgkmcnt(2)
  s_waitcnt vmcnt(1)
  s_barrier
  s_add_u32 s62, s33, 0
  s_cmp_lg_u32 s3, 0
  s_cbranch_scc1 L_sig_115
  v_lshlrev_b32 v250, 7, v2
  s_lshl_b32 s60, s62, 7
  v_add_u32 v250, s60, v250
  v_mov_b32 v251, 1
  s_mov_b64 exec, 1
  buffer_atomic_add v251, v250, s[92:95], 0 offen sc1
  s_mov_b64 exec, -1
L_sig_115:
  v_mfma_f32_32x32x16_bf16 v[16:31], a[136:139], v[84:87], v[16:31]
  ds_read_b128 v[80:83], v3 offset:20480
  v_mul_f32 v72, v56, v72
  v_mul_f32 v73, v57, v73
  v_mul_f32 v74, v58, v74
  v_mfma_f32_32x32x16_bf16 v[32:47], a[140:143], v[84:87], v[32:47]
  v_mul_f32 v75, v59, v75
  v_mul_f32 v76, v60, v76
  s_waitcnt lgkmcnt(2)
  v_mfma_f32_32x32x16_bf16 v[16:31], a[144:147], v[88:91], v[16:31]
  ds_read_b128 v[84:87], v3 offset:21504
  v_mul_f32 v77, v61, v77
  v_mul_f32 v78, v62, v78
  v_mfma_f32_32x32x16_bf16 v[32:47], a[148:151], v[88:91], v[32:47]
  v_mul_f32 v79, v63, v79
  v_add_f32 v96, 1.0, v96
  s_waitcnt lgkmcnt(2)
  v_mfma_f32_32x32x16_bf16 v[16:31], a[152:155], v[92:95], v[16:31]
  ds_read_b128 v[88:91], v3 offset:22528
  v_add_f32 v97, 1.0, v97
  v_add_f32 v98, 1.0, v98
  v_mfma_f32_32x32x16_bf16 v[32:47], a[156:159], v[92:95], v[32:47]
  v_add_f32 v99, 1.0, v99
  v_add_f32 v100, 1.0, v100
  v_add_f32 v101, 1.0, v101
  s_waitcnt lgkmcnt(2)
  v_mfma_f32_32x32x16_bf16 v[16:31], a[160:163], v[80:83], v[16:31]
  ds_read_b128 v[92:95], v3 offset:23552
  v_add_f32 v102, 1.0, v102
  v_add_f32 v103, 1.0, v103
  v_mfma_f32_32x32x16_bf16 v[32:47], a[164:167], v[80:83], v[32:47]
  v_rcp_f32 v96, v96
  v_rcp_f32 v97, v97
  s_waitcnt lgkmcnt(2)
  v_mfma_f32_32x32x16_bf16 v[16:31], a[168:171], v[84:87], v[16:31]
  ds_read_b128 v[80:83], v3 offset:24576
  v_rcp_f32 v98, v98
  v_rcp_f32 v99, v99
  v_mfma_f32_32x32x16_bf16 v[32:47], a[172:175], v[84:87], v[32:47]
  v_rcp_f32 v100, v100
  v_rcp_f32 v101, v101
  s_waitcnt lgkmcnt(2)
  v_mfma_f32_32x32x16_bf16 v[16:31], a[176:179], v[88:91], v[16:31]
  ds_read_b128 v[84:87], v3 offset:25600
  v_rcp_f32 v102, v102
  v_rcp_f32 v103, v103
  v_mfma_f32_32x32x16_bf16 v[32:47], a[180:183], v[88:91], v[32:47]
  v_mul_f32 v72, v72, v96
  v_mul_f32 v73, v73, v97
  v_mul_f32 v74, v74, v98
  s_waitcnt lgkmcnt(2)
  v_mfma_f32_32x32x16_bf16 v[16:31], a[184:187], v[92:95], v[16:31]
  ds_read_b128 v[88:91], v3 offset:26624
  v_mul_f32 v75, v75, v99
  v_mul_f32 v76, v76, v100
  v_mfma_f32_32x32x16_bf16 v[32:47], a[188:191], v[92:95], v[32:47]
  v_mul_f32 v77, v77, v101
  v_mul_f32 v78, v78, v102
  s_waitcnt lgkmcnt(2)
  v_mfma_f32_32x32x16_bf16 v[16:31], a[192:195], v[80:83], v[16:31]
  ds_read_b128 v[92:95], v3 offset:27648
  v_mul_f32 v79, v79, v103
  v_cvt_pk_bf16_f32 v56, v72, v73
  v_mfma_f32_32x32x16_bf16 v[32:47], a[196:199], v[80:83], v[32:47]
  v_cvt_pk_bf16_f32 v57, v74, v75
  v_cvt_pk_bf16_f32 v58, v76, v77
  s_waitcnt lgkmcnt(2)
  v_mfma_f32_32x32x16_bf16 v[16:31], a[200:203], v[84:87], v[16:31]
  ds_read_b128 v[80:83], v3 offset:28672
  v_cvt_pk_bf16_f32 v59, v78, v79
  buffer_store_dwordx4 v[56:59], v3, s[24:27], s41 offen offset:1024 sc1
  v_mfma_f32_32x32x16_bf16 v[32:47], a[204:207], v[84:87], v[32:47]
  s_waitcnt lgkmcnt(2)
  v_mfma_f32_32x32x16_bf16 v[16:31], a[208:211], v[88:91], v[16:31]
  ds_read_b128 v[84:87], v3 offset:29696
  v_mfma_f32_32x32x16_bf16 v[32:47], a[212:215], v[88:91], v[32:47]
  s_waitcnt lgkmcnt(2)
  v_mfma_f32_32x32x16_bf16 v[16:31], a[216:219], v[92:95], v[16:31]
  ds_read_b128 v[88:91], v3 offset:30720
  v_mfma_f32_32x32x16_bf16 v[32:47], a[220:223], v[92:95], v[32:47]
  s_waitcnt lgkmcnt(2)
  v_mfma_f32_32x32x16_bf16 v[48:63], a[0:3], v[80:83], 0
  ds_read_b128 v[92:95], v3 offset:31744
  v_mfma_f32_32x32x16_bf16 v[64:79], a[4:7], v[80:83], 0
  s_waitcnt lgkmcnt(2)
  v_mfma_f32_32x32x16_bf16 v[48:63], a[8:11], v[84:87], v[48:63]
  ds_read_b128 v[80:83], v3 offset:32768
  s_add_u32 s41, s32, 2
  s_mul_i32 s41, s41, 112*1024
  s_add_u32 s41, s41, s40
  v_mul_f32 v96, 0xbfb8aa3b, v16
  v_mul_f32 v97, 0xbfb8aa3b, v17
  v_mfma_f32_32x32x16_bf16 v[64:79], a[12:15], v[84:87], v[64:79]
  v_mul_f32 v98, 0xbfb8aa3b, v18
  v_mul_f32 v99, 0xbfb8aa3b, v19
  s_waitcnt lgkmcnt(2)
  v_mfma_f32_32x32x16_bf16 v[48:63], a[16:19], v[88:91], v[48:63]
  ds_read_b128 v[84:87], v3 offset:33792
  v_mul_f32 v100, 0xbfb8aa3b, v20
  v_mul_f32 v101, 0xbfb8aa3b, v21
  v_mfma_f32_32x32x16_bf16 v[64:79], a[20:23], v[88:91], v[64:79]
  v_mul_f32 v102, 0xbfb8aa3b, v22
  v_mul_f32 v103, 0xbfb8aa3b, v23
  s_waitcnt lgkmcnt(2)
  v_mfma_f32_32x32x16_bf16 v[48:63], a[24:27], v[92:95], v[48:63]
  ds_read_b128 v[88:91], v3 offset:34816
  v_exp_f32 v96, v96
  v_exp_f32 v97, v97
  v_exp_f32 v98, v98
  v_mfma_f32_32x32x16_bf16 v[64:79], a[28:31], v[92:95], v[64:79]
  v_exp_f32 v99, v99
  v_exp_f32 v100, v100
  s_waitcnt lgkmcnt(2)
  v_mfma_f32_32x32x16_bf16 v[48:63], a[32:35], v[80:83], v[48:63]
  ds_read_b128 v[92:95], v3 offset:35840
  v_exp_f32 v101, v101
  v_exp_f32 v102, v102
  v_mfma_f32_32x32x16_bf16 v[64:79], a[36:39], v[80:83], v[64:79]
  v_exp_f32 v103, v103
  v_mul_f32 v32, v16, v32
  s_waitcnt lgkmcnt(2)
  v_mfma_f32_32x32x16_bf16 v[48:63], a[40:43], v[84:87], v[48:63]
  ds_read_b128 v[80:83], v3 offset:36864
  v_mul_f32 v33, v17, v33
  v_mul_f32 v34, v18, v34
  v_mfma_f32_32x32x16_bf16 v[64:79], a[44:47], v[84:87], v[64:79]
  v_mul_f32 v35, v19, v35
  v_mul_f32 v36, v20, v36
  s_waitcnt lgkmcnt(2)
  v_mfma_f32_32x32x16_bf16 v[48:63], a[48:51], v[88:91], v[48:63]
  ds_read_b128 v[84:87], v3 offset:37888
  v_mul_f32 v37, v21, v37
  v_mul_f32 v38, v22, v38
  v_mul_f32 v39, v23, v39
  v_mfma_f32_32x32x16_bf16 v[64:79], a[52:55], v[88:91], v[64:79]
  v_add_f32 v96, 1.0, v96
  v_add_f32 v97, 1.0, v97
  s_waitcnt lgkmcnt(2)
  v_mfma_f32_32x32x16_bf16 v[48:63], a[56:59], v[92:95], v[48:63]
  ds_read_b128 v[88:91], v3 offset:38912
  v_add_f32 v98, 1.0, v98
  v_add_f32 v99, 1.0, v99
  v_mfma_f32_32x32x16_bf16 v[64:79], a[60:63], v[92:95], v[64:79]
  v_add_f32 v100, 1.0, v100
  v_add_f32 v101, 1.0, v101
  s_waitcnt lgkmcnt(2)
  v_mfma_f32_32x32x16_bf16 v[48:63], a[64:67], v[80:83], v[48:63]
  ds_read_b128 v[92:95], v3 offset:39936
  v_add_f32 v102, 1.0, v102
  v_add_f32 v103, 1.0, v103
  v_mfma_f32_32x32x16_bf16 v[64:79], a[68:71], v[80:83], v[64:79]
  v_rcp_f32 v96, v96
  v_rcp_f32 v97, v97
  v_rcp_f32 v98, v98
  s_waitcnt lgkmcnt(2)
  v_mfma_f32_32x32x16_bf16 v[48:63], a[72:75], v[84:87], v[48:63]
  ds_read_b128 v[80:83], v3 offset:40960
  v_rcp_f32 v99, v99
  v_rcp_f32 v100, v100
  v_mfma_f32_32x32x16_bf16 v[64:79], a[76:79], v[84:87], v[64:79]
  v_rcp_f32 v101, v101
  v_rcp_f32 v102, v102
  s_waitcnt lgkmcnt(2)
  v_mfma_f32_32x32x16_bf16 v[48:63], a[80:83], v[88:91], v[48:63]
  ds_read_b128 v[84:87], v3 offset:41984
  v_rcp_f32 v103, v103
  v_mul_f32 v32, v32, v96
  v_mfma_f32_32x32x16_bf16 v[64:79], a[84:87], v[88:91], v[64:79]
  v_mul_f32 v33, v33, v97
  v_mul_f32 v34, v34, v98
  s_waitcnt lgkmcnt(2)
  v_mfma_f32_32x32x16_bf16 v[48:63], a[88:91], v[92:95], v[48:63]
  ds_read_b128 v[88:91], v3 offset:43008
  v_mul_f32 v35, v35, v99
  v_mul_f32 v36, v36, v100
  v_mfma_f32_32x32x16_bf16 v[64:79], a[92:95], v[92:95], v[64:79]
  v_mul_f32 v37, v37, v101
  v_mul_f32 v38, v38, v102
  v_mul_f32 v39, v39, v103
  s_waitcnt lgkmcnt(2)
  v_mfma_f32_32x32x16_bf16 v[48:63], a[96:99], v[80:83], v[48:63]
  ds_read_b128 v[92:95], v3 offset:44032
  v_cvt_pk_bf16_f32 v16, v32, v33
  v_cvt_pk_bf16_f32 v17, v34, v35
  v_mfma_f32_32x32x16_bf16 v[64:79], a[100:103], v[80:83], v[64:79]
  v_cvt_pk_bf16_f32 v18, v36, v37
  v_cvt_pk_bf16_f32 v19, v38, v39
  s_waitcnt lgkmcnt(2)
  v_mfma_f32_32x32x16_bf16 v[48:63], a[104:107], v[84:87], v[48:63]
  ds_read_b128 v[80:83], v3 offset:45056
  buffer_store_dwordx4 v[16:19], v3, s[24:27], s41 offen offset:0 sc1
  v_mul_f32 v96, 0xbfb8aa3b, v24
  v_mfma_f32_32x32x16_bf16 v[64:79], a[108:111], v[84:87], v[64:79]
  v_mul_f32 v97, 0xbfb8aa3b, v25
  v_mul_f32 v98, 0xbfb8aa3b, v26
  s_waitcnt lgkmcnt(2)
  v_mfma_f32_32x32x16_bf16 v[48:63], a[112:115], v[88:91], v[48:63]
  ds_read_b128 v[84:87], v3 offset:46080
  v_mul_f32 v99, 0xbfb8aa3b, v27
  v_mul_f32 v100, 0xbfb8aa3b, v28
  v_mul_f32 v101, 0xbfb8aa3b, v29
  v_mfma_f32_32x32x16_bf16 v[64:79], a[116:119], v[88:91], v[64:79]
  v_mul_f32 v102, 0xbfb8aa3b, v30
  v_mul_f32 v103, 0xbfb8aa3b, v31
  s_waitcnt lgkmcnt(2)
  v_mfma_f32_32x32x16_bf16 v[48:63], a[120:123], v[92:95], v[48:63]
  ds_read_b128 v[88:91], v3 offset:47104
  v_exp_f32 v96, v96
  v_exp_f32 v97, v97
  v_mfma_f32_32x32x16_bf16 v[64:79], a[124:127], v[92:95], v[64:79]
  v_exp_f32 v98, v98
  v_exp_f32 v99, v99
  s_waitcnt lgkmcnt(2)
  v_mfma_f32_32x32x16_bf16 v[48:63], a[128:131], v[80:83], v[48:63]
  ds_read_b128 v[92:95], v3 offset:48128
  v_exp_f32 v100, v100
  v_exp_f32 v101, v101
  v_mfma_f32_32x32x16_bf16 v[64:79], a[132:135], v[80:83], v[64:79]
  v_exp_f32 v102, v102
  v_exp_f32 v103, v103
  s_waitcnt vmcnt(1)
  s_barrier
  s_add_u32 s62, s33, 1
  s_cmp_lg_u32 s3, 0
  s_cbranch_scc1 L_sig_116
  v_lshlrev_b32 v250, 7, v2
  s_lshl_b32 s60, s62, 7
  v_add_u32 v250, s60, v250
  v_mov_b32 v251, 1
  s_mov_b64 exec, 1
  buffer_atomic_add v251, v250, s[92:95], 0 offen sc1
  s_mov_b64 exec, -1
L_sig_116:
  s_waitcnt lgkmcnt(2)
  v_mfma_f32_32x32x16_bf16 v[48:63], a[136:139], v[84:87], v[48:63]
  ds_read_b128 v[80:83], v3 offset:49152
  v_mul_f32 v40, v24, v40
  v_mul_f32 v41, v25, v41
  v_mul_f32 v42, v26, v42
  v_mfma_f32_32x32x16_bf16 v[64:79], a[140:143], v[84:87], v[64:79]
  v_mul_f32 v43, v27, v43
  v_mul_f32 v44, v28, v44
  s_waitcnt lgkmcnt(2)
  v_mfma_f32_32x32x16_bf16 v[48:63], a[144:147], v[88:91], v[48:63]
  ds_read_b128 v[84:87], v3 offset:50176
  v_mul_f32 v45, v29, v45
  v_mul_f32 v46, v30, v46
  v_mfma_f32_32x32x16_bf16 v[64:79], a[148:151], v[88:91], v[64:79]
  v_mul_f32 v47, v31, v47
  v_add_f32 v96, 1.0, v96
  s_waitcnt lgkmcnt(2)
  v_mfma_f32_32x32x16_bf16 v[48:63], a[152:155], v[92:95], v[48:63]
  ds_read_b128 v[88:91], v3 offset:51200
  v_add_f32 v97, 1.0, v97
  v_add_f32 v98, 1.0, v98
  v_mfma_f32_32x32x16_bf16 v[64:79], a[156:159], v[92:95], v[64:79]
  v_add_f32 v99, 1.0, v99
  v_add_f32 v100, 1.0, v100
  v_add_f32 v101, 1.0, v101
  s_cmp_lg_u32 s3, 0
  s_cbranch_scc1 L_pi_117
  v_lshlrev_b32 v252, 7, v2
  s_lshl_b32 s60, s56, 7
  v_add_u32 v252, s60, v252
  s_mov_b64 exec, 1
  buffer_load_dword v253, v252, s[92:95], 0 offen sc1
  s_mov_b64 exec, -1
L_pi_117:
  s_waitcnt lgkmcnt(2)
  v_mfma_f32_32x32x16_bf16 v[48:63], a[160:163], v[80:83], v[48:63]
  ds_read_b128 v[92:95], v3 offset:52224
  v_add_f32 v102, 1.0, v102
  v_add_f32 v103, 1.0, v103
  v_mfma_f32_32x32x16_bf16 v[64:79], a[164:167], v[80:83], v[64:79]
  v_rcp_f32 v96, v96
  v_rcp_f32 v97, v97
  s_waitcnt lgkmcnt(2)
  v_mfma_f32_32x32x16_bf16 v[48:63], a[168:171], v[84:87], v[48:63]
  ds_read_b128 v[80:83], v3 offset:53248
  v_rcp_f32 v98, v98
  v_rcp_f32 v99, v99
  v_mfma_f32_32x32x16_bf16 v[64:79], a[172:175], v[84:87], v[64:79]
  v_rcp_f32 v100, v100
  v_rcp_f32 v101, v101
  s_waitcnt lgkmcnt(2)
  v_mfma_f32_32x32x16_bf16 v[48:63], a[176:179], v[88:91], v[48:63]
  ds_read_b128 v[84:87], v3 offset:54272
  v_rcp_f32 v102, v102
  v_rcp_f32 v103, v103
  v_mfma_f32_32x32x16_bf16 v[64:79], a[180:183], v[88:91], v[64:79]
  v_mul_f32 v40, v40, v96
  v_mul_f32 v41, v41, v97
  v_mul_f32 v42, v42, v98
  s_waitcnt lgkmcnt(2)
  v_mfma_f32_32x32x16_bf16 v[48:63], a[184:187], v[92:95], v[48:63]
  ds_read_b128 v[88:91], v3 offset:55296
  v_mul_f32 v43, v43, v99
  v_mul_f32 v44, v44, v100
  v_mfma_f32_32x32x16_bf16 v[64:79], a[188:191], v[92:95], v[64:79]
  v_mul_f32 v45, v45, v101
  v_mul_f32 v46, v46, v102
  s_waitcnt lgkmcnt(2)
  v_mfma_f32_32x32x16_bf16 v[48:63], a[192:195], v[80:83], v[48:63]
  ds_read_b128 v[92:95], v3 offset:56320
  v_mul_f32 v47, v47, v103
  v_cvt_pk_bf16_f32 v24, v40, v41
  v_mfma_f32_32x32x16_bf16 v[64:79], a[196:199], v[80:83], v[64:79]
  v_cvt_pk_bf16_f32 v25, v42, v43
  v_cvt_pk_bf16_f32 v26, v44, v45
  s_waitcnt lgkmcnt(2)
  v_mfma_f32_32x32x16_bf16 v[48:63], a[200:203], v[84:87], v[48:63]
  v_cvt_pk_bf16_f32 v27, v46, v47
  buffer_store_dwordx4 v[24:27], v3, s[24:27], s41 offen offset:1024 sc1
  v_mfma_f32_32x32x16_bf16 v[64:79], a[204:207], v[84:87], v[64:79]
  s_waitcnt lgkmcnt(1)
  v_mfma_f32_32x32x16_bf16 v[48:63], a[208:211], v[88:91], v[48:63]
  v_mfma_f32_32x32x16_bf16 v[64:79], a[212:215], v[88:91], v[64:79]
  s_waitcnt lgkmcnt(0)
  v_mfma_f32_32x32x16_bf16 v[48:63], a[216:219], v[92:95], v[48:63]
  v_mfma_f32_32x32x16_bf16 v[64:79], a[220:223], v[92:95], v[64:79]
  s_cmp_lg_u32 s3, 0
  s_cbranch_scc1 L_pc_118
  s_waitcnt vmcnt(1)
  s_mov_b64 exec, 1
  v_cmp_le_u32 vcc, 14, v253
  s_nop 2
  s_cmp_eq_u64 vcc, exec
  s_mov_b64 exec, -1
  s_cbranch_scc1 L_pc_118
  s_cmp_lg_u32 s3, 0
  s_cbranch_scc1 L_wt_119
  v_lshlrev_b32 v250, 7, v2
  s_lshl_b32 s60, s56, 7
  v_add_u32 v250, s60, v250
  s_mov_b64 exec, 1
  s_mov_b32 s61, 0
L_pl_120:
  buffer_load_dword v251, v250, s[92:95], 0 offen sc1
  s_add_u32 s61, s61, 1
  s_waitcnt vmcnt(0)
  v_cmp_le_u32 vcc, 14, v251
  s_nop 2
  s_cmp_eq_u64 vcc, exec
  s_cbranch_scc1 L_pd_121
  s_sleep 6
  s_cmp_lt_u32 s61, 400000
  s_cbranch_scc1 L_pl_120
L_pd_121:
  s_mov_b64 exec, -1
L_wt_119:
L_pc_118:
  s_waitcnt lgkmcnt(0)
  s_barrier
  s_add_u32 s41, s32, 3
  s_mul_i32 s41, s41, 112*1024
  s_add_u32 s41, s41, s40
  v_mul_f32 v96, 0xbfb8aa3b, v48
  v_mul_f32 v97, 0xbfb8aa3b, v49
  v_mul_f32 v98, 0xbfb8aa3b, v50
  v_mul_f32 v99, 0xbfb8aa3b, v51
  v_mul_f32 v100, 0xbfb8aa3b, v52
  v_mul_f32 v101, 0xbfb8aa3b, v53
  v_mul_f32 v102, 0xbfb8aa3b, v54
  v_mul_f32 v103, 0xbfb8aa3b, v55
  v_exp_f32 v96, v96
  v_exp_f32 v97, v97
  v_exp_f32 v98, v98
  v_exp_f32 v99, v99
  v_exp_f32 v100, v100
  v_exp_f32 v101, v101
  v_exp_f32 v102, v102
  v_exp_f32 v103, v103
  v_mul_f32 v64, v48, v64
  v_mul_f32 v65, v49, v65
  v_mul_f32 v66, v50, v66
  v_mul_f32 v67, v51, v67
  v_mul_f32 v68, v52, v68
  v_mul_f32 v69, v53, v69
  v_mul_f32 v70, v54, v70
  v_mul_f32 v71, v55, v71
  v_add_f32 v96, 1.0, v96
  v_add_f32 v97, 1.0, v97
  v_add_f32 v98, 1.0, v98
  v_add_f32 v99, 1.0, v99
  v_add_f32 v100, 1.0, v100
  v_add_f32 v101, 1.0, v101
  v_add_f32 v102, 1.0, v102
  v_add_f32 v103, 1.0, v103
  v_rcp_f32 v96, v96
  v_rcp_f32 v97, v97
  v_rcp_f32 v98, v98
  v_rcp_f32 v99, v99
  v_rcp_f32 v100, v100
  v_rcp_f32 v101, v101
  v_rcp_f32 v102, v102
  v_rcp_f32 v103, v103
  v_mul_f32 v64, v64, v96
  v_mul_f32 v65, v65, v97
  v_mul_f32 v66, v66, v98
  v_mul_f32 v67, v67, v99
  v_mul_f32 v68, v68, v100
  v_mul_f32 v69, v69, v101
  v_mul_f32 v70, v70, v102
  v_mul_f32 v71, v71, v103
  v_cvt_pk_bf16_f32 v48, v64, v65
  v_cvt_pk_bf16_f32 v49, v66, v67
  v_cvt_pk_bf16_f32 v50, v68, v69
  v_cvt_pk_bf16_f32 v51, v70, v71
  buffer_store_dwordx4 v[48:51], v3, s[24:27], s41 offen offset:0 sc1
  v_mul_f32 v96, 0xbfb8aa3b, v56
  v_mul_f32 v97, 0xbfb8aa3b, v57
  v_mul_f32 v98, 0xbfb8aa3b, v58
  v_mul_f32 v99, 0xbfb8aa3b, v59
  v_mul_f32 v100, 0xbfb8aa3b, v60
  v_mul_f32 v101, 0xbfb8aa3b, v61
  v_mul_f32 v102, 0xbfb8aa3b, v62
  v_mul_f32 v103, 0xbfb8aa3b, v63
  v_exp_f32 v96, v96
  v_exp_f32 v97, v97
  v_exp_f32 v98, v98
  v_exp_f32 v99, v99
  v_exp_f32 v100, v100
  v_exp_f32 v101, v101
  v_exp_f32 v102, v102
  v_exp_f32 v103, v103
  v_mul_f32 v72, v56, v72
  v_mul_f32 v73, v57, v73
  v_mul_f32 v74, v58, v74
  v_mul_f32 v75, v59, v75
  v_mul_f32 v76, v60, v76
  v_mul_f32 v77, v61, v77
  v_mul_f32 v78, v62, v78
  v_mul_f32 v79, v63, v79
  v_add_f32 v96, 1.0, v96
  v_add_f32 v97, 1.0, v97
  v_add_f32 v98, 1.0, v98
  v_add_f32 v99, 1.0, v99
  v_add_f32 v100, 1.0, v100
  v_add_f32 v101, 1.0, v101
  v_add_f32 v102, 1.0, v102
  v_add_f32 v103, 1.0, v103
  v_rcp_f32 v96, v96
  v_rcp_f32 v97, v97
  v_rcp_f32 v98, v98
  v_rcp_f32 v99, v99
  v_rcp_f32 v100, v100
  v_rcp_f32 v101, v101
  v_rcp_f32 v102, v102
  v_rcp_f32 v103, v103
  v_mul_f32 v72, v72, v96
  v_mul_f32 v73, v73, v97
  v_mul_f32 v74, v74, v98
  v_mul_f32 v75, v75, v99
  v_mul_f32 v76, v76, v100
  v_mul_f32 v77, v77, v101
  v_mul_f32 v78, v78, v102
  v_mul_f32 v79, v79, v103
  v_cvt_pk_bf16_f32 v56, v72, v73
  v_cvt_pk_bf16_f32 v57, v74, v75
  v_cvt_pk_bf16_f32 v58, v76, v77
  v_cvt_pk_bf16_f32 v59, v78, v79
  buffer_store_dwordx4 v[56:59], v3, s[24:27], s41 offen offset:1024 sc1
  buffer_load_dwordx4 v[112:115], v3, s[24:27], s22 offen offset:0 sc1
  buffer_load_dwordx4 v[116:119], v3, s[24:27], s22 offen offset:1024 sc1
  buffer_load_dwordx4 v[120:123], v3, s[24:27], s22 offen offset:2048 sc1
  buffer_load_dwordx4 v[124:127], v3, s[24:27], s22 offen offset:3072 sc1
  s_add_u32 s22, s22, 4096
  buffer_load_dwordx4 v[128:131], v3, s[24:27], s22 offen offset:0 sc1
  buffer_load_dwordx4 v[132:135], v3, s[24:27], s22 offen offset:1024 sc1
  buffer_load_dwordx4 v[136:139], v3, s[24:27], s22 offen offset:2048 sc1
  buffer_load_dwordx4 v[140:143], v3, s[24:27], s22 offen offset:3072 sc1
  s_add_u32 s22, s22, 4096
  buffer_load_dwordx4 v[144:147], v3, s[24:27], s22 offen offset:0 sc1
  buffer_load_dwordx4 v[148:151], v3, s[24:27], s22 offen offset:1024 sc1
  buffer_load_dwordx4 v[152:155], v3, s[24:27], s22 offen offset:2048 sc1
  buffer_load_dwordx4 v[156:159], v3, s[24:27], s22 offen offset:3072 sc1
  s_add_u32 s22, s22, 4096
  buffer_load_dwordx4 v[160:163], v3, s[24:27], s22 offen offset:0 sc1
  buffer_load_dwordx4 v[164:167], v3, s[24:27], s22 offen offset:1024 sc1
  s_waitcnt vmcnt(14)
  s_barrier
  s_add_u32 s59, s33, 2
  s_cmp_lg_u32 s3, 0
  s_cbranch_scc1 L_sig_122
  v_lshlrev_b32 v250, 7, v2
  s_lshl_b32 s60, s59, 7
  v_add_u32 v250, s60, v250
  v_mov_b32 v251, 1
  s_mov_b64 exec, 3
  buffer_atomic_add v251, v250, s[92:95], 0 offen sc1
  s_mov_b64 exec, -1
L_sig_122:
  ds_read_b128 v[88:91], v6 offset:0
  ds_read_b128 v[92:95], v6 offset:1024
  ds_read_b128 v[96:99], v6 offset:2048
  s_add_u32 s16, s88, 0xc00000
  s_addc_u32 s17, s89, 0
  s_mov_b32 s18, 0x1c0000
  s_mov_b32 s19, 0x20000
  v_and_b32 v4, 31, v2
  v_lshrrev_b32 v5, 5, v2
  s_and_b32 s13, s3, 1
  s_lshr_b32 s12, s3, 1
  s_lshl_b32 s14, s49, 12
  s_lshl_b32 s15, s13, 11
  s_add_u32 s14, s14, s15
  s_lshl_b32 s15, s12, 10
  s_add_u32 s14, s14, s15
  v_lshlrev_b32 v7, 9, v5
  v_lshl_add_u32 v7, v4, 4, v7
  v_add_u32 v7, s14, v7
  s_mul_i32 s34, s42, 28672
  s_mul_i32 s35, s43, 28672
  s_lshl_b32 s14, s3, 11
  v_add_u32 v8, s14, v3
  s_lshl_b32 s14, s3, 13
  v_add_u32 v9, s14, v3
  s_mov_b32 s36, s84
  s_mov_b32 s37, s85
  s_mov_b32 s38, 0x1c0000
  s_mov_b32 s39, 0x20000
  s_lshl_b32 s14, s49, 7
  s_lshl_b32 s13, s13, 6
  s_add_u32 s14, s14, s13
  s_lshl_b32 s12, s12, 5
  s_add_u32 s14, s14, s12
  v_mul_u32_u24 v10, 896, v4
  v_lshl_add_u32 v10, v5, 4, v10
  v_add_u32 v10, s14, v10
  s_mul_i32 s40, s42, 32*896
  s_mul_i32 s41, s43, 32*896
  s_waitcnt vmcnt(13)
  v_mfma_f32_32x32x16_bf16 v[16:31], a[224:227], v[112:115], 0
  s_waitcnt lgkmcnt(2)
  v_mfma_f32_32x32x16_bf16 v[32:47], v[88:91], v[112:115], 0
  ds_read_b128 v[100:103], v6 offset:3072
  buffer_load_dwordx4 v[112:115], v3, s[24:27], s22 offen offset:2048 sc1
  s_waitcnt vmcnt(13)
  v_mfma_f32_32x32x16_bf16 v[16:31], a[228:231], v[116:119], v[16:31]
  s_waitcnt lgkmcnt(2)
  v_mfma_f32_32x32x16_bf16 v[32:47], v[92:95], v[116:119], v[32:47]
  ds_read_b128 v[88:91], v6 offset:4096
  buffer_load_dwordx4 v[116:119], v3, s[24:27], s22 offen offset:3072 sc1
  s_waitcnt vmcnt(13)
  v_mfma_f32_32x32x16_bf16 v[16:31], a[232:235], v[120:123], v[16:31]
  s_waitcnt lgkmcnt(2)
  v_mfma_f32_32x32x16_bf16 v[32:47], v[96:99], v[120:123], v[32:47]
  ds_read_b128 v[92:95], v6 offset:5120
  s_add_u32 s22, s22, 4096
  buffer_load_dwordx4 v[120:123], v3, s[24:27], s22 offen offset:0 sc1
  s_waitcnt vmcnt(13)
  v_mfma_f32_32x32x16_bf16 v[16:31], a[236:239], v[124:127], v[16:31]
  s_waitcnt lgkmcnt(2)
  v_mfma_f32_32x32x16_bf16 v[32:47], v[100:103], v[124:127], v[32:47]
  ds_read_b128 v[96:99], v6 offset:6144
  buffer_load_dwordx4 v[124:127], v3, s[24:27], s22 offen offset:1024 sc1
  s_waitcnt vmcnt(13)
  v_mfma_f32_32x32x16_bf16 v[16:31], a[240:243], v[128:131], v[16:31]
  s_waitcnt lgkmcnt(2)
  v_mfma_f32_32x32x16_bf16 v[32:47], v[88:91], v[128:131], v[32:47]
  ds_read_b128 v[100:103], v6 offset:7168
  buffer_load_dwordx4 v[128:131], v3, s[24:27], s22 offen offset:2048 sc1
  s_waitcnt vmcnt(13)
  v_mfma_f32_32x32x16_bf16 v[16:31], a[244:247], v[132:135], v[16:31]
  s_waitcnt lgkmcnt(2)
  v_mfma_f32_32x32x16_bf16 v[32:47], v[92:95], v[132:135], v[32:47]
  ds_read_b128 v[88:91], v6 offset:8192
  buffer_load_dwordx4 v[132:135], v3, s[24:27], s22 offen offset:3072 sc1
  s_waitcnt vmcnt(13)
  v_mfma_f32_32x32x16_bf16 v[16:31], a[248:251], v[136:139], v[16:31]
  s_waitcnt lgkmcnt(2)
  v_mfma_f32_32x32x16_bf16 v[32:47], v[96:99], v[136:139], v[32:47]
  ds_read_b128 v[92:95], v6 offset:9216
  s_add_u32 s22, s22, 4096
  buffer_load_dwordx4 v[136:139], v3, s[24:27], s22 offen offset:0 sc1
  s_waitcnt vmcnt(13)
  v_mfma_f32_32x32x16_bf16 v[16:31], a[252:255], v[140:143], v[16:31]
  s_waitcnt lgkmcnt(2)
  v_mfma_f32_32x32x16_bf16 v[32:47], v[100:103], v[140:143], v[32:47]
  ds_read_b128 v[96:99], v6 offset:10240
  buffer_load_dwordx4 v[140:143], v3, s[24:27], s22 offen offset:1024 sc1
  s_waitcnt vmcnt(13)
  v_mfma_f32_32x32x16_bf16 v[16:31], v[168:171], v[144:147], v[16:31]
  s_waitcnt lgkmcnt(2)
  v_mfma_f32_32x32x16_bf16 v[32:47], v[88:91], v[144:147], v[32:47]
  ds_read_b128 v[100:103], v6 offset:11264
  buffer_load_dwordx4 v[144:147], v3, s[24:27], s22 offen offset:2048 sc1
  s_waitcnt vmcnt(13)
  v_mfma_f32_32x32x16_bf16 v[16:31], v[172:175], v[148:151], v[16:31]
  s_waitcnt lgkmcnt(2)
  v_mfma_f32_32x32x16_bf16 v[32:47], v[92:95], v[148:151], v[32:47]
  ds_read_b128 v[88:91], v6 offset:12288
  buffer_load_dwordx4 v[148:151], v3, s[24:27], s22 offen offset:3072 sc1
  s_waitcnt vmcnt(13)
  v_mfma_f32_32x32x16_bf16 v[16:31], v[176:179], v[152:155], v[16:31]
  s_waitcnt lgkmcnt(2)
  v_mfma_f32_32x32x16_bf16 v[32:47], v[96:99], v[152:155], v[32:47]
  ds_read_b128 v[92:95], v6 offset:13312
  s_add_u32 s22, s22, 4096
  buffer_load_dwordx4 v[152:155], v3, s[24:27], s22 offen offset:0 sc1
  s_waitcnt vmcnt(13)
  v_mfma_f32_32x32x16_bf16 v[16:31], v[180:183], v[156:159], v[16:31]
  s_waitcnt lgkmcnt(2)
  v_mfma_f32_32x32x16_bf16 v[32:47], v[100:103], v[156:159], v[32:47]
  ds_read_b128 v[96:99], v6 offset:14336
  buffer_load_dwordx4 v[156:159], v3, s[24:27], s22 offen offset:1024 sc1
  s_waitcnt vmcnt(13)
  v_mfma_f32_32x32x16_bf16 v[16:31], v[184:187], v[160:163], v[16:31]
  s_waitcnt lgkmcnt(2)
  v_mfma_f32_32x32x16_bf16 v[32:47], v[88:91], v[160:163], v[32:47]
  ds_read_b128 v[100:103], v6 offset:15360
  buffer_load_dwordx4 v[160:163], v3, s[24:27], s22 offen offset:2048 sc1
  s_waitcnt vmcnt(13)
  v_mfma_f32_32x32x16_bf16 v[16:31], v[188:191], v[164:167], v[16:31]
  s_waitcnt lgkmcnt(2)
  v_mfma_f32_32x32x16_bf16 v[32:47], v[92:95], v[164:167], v[32:47]
  ds_read_b128 v[88:91], v6 offset:16384
  buffer_load_dwordx4 v[164:167], v3, s[24:27], s22 offen offset:3072 sc1
  s_cmp_lg_u32 s3, 0
  s_cbranch_scc1 L_wt_123
  v_lshlrev_b32 v250, 7, v2
  s_lshl_b32 s60, s57, 7
  v_add_u32 v250, s60, v250
  s_mov_b64 exec, 1
  s_mov_b32 s61, 0
L_pl_124:
  buffer_load_dword v251, v250, s[92:95], 0 offen sc1
  s_add_u32 s61, s61, 1
  s_waitcnt vmcnt(0)
  v_cmp_le_u32 vcc, 14, v251
  s_nop 2
  s_cmp_eq_u64 vcc, exec
  s_cbranch_scc1 L_pd_125
  s_sleep 6
  s_cmp_lt_u32 s61, 400000
  s_cbranch_scc1 L_pl_124
L_pd_125:
  s_mov_b64 exec, -1
L_wt_123:
  s_barrier
  buffer_load_dwordx4 v[80:83], v7, s[16:19], s34 offen sc1
  buffer_load_dwordx4 v[84:87], v7, s[16:19], s35 offen sc1
  s_waitcnt vmcnt(15)
  v_mfma_f32_32x32x16_bf16 v[16:31], v[192:195], v[112:115], v[16:31]
  s_waitcnt lgkmcnt(2)
  v_mfma_f32_32x32x16_bf16 v[32:47], v[96:99], v[112:115], v[32:47]
  ds_read_b128 v[92:95], v6 offset:17408
  buffer_load_dwordx4 v[112:115], v3, s[24:27], s23 offen offset:0 sc1
  s_waitcnt vmcnt(15)
  v_mfma_f32_32x32x16_bf16 v[16:31], v[196:199], v[116:119], v[16:31]
  s_waitcnt lgkmcnt(2)
  v_mfma_f32_32x32x16_bf16 v[32:47], v[100:103], v[116:119], v[32:47]
  ds_read_b128 v[96:99], v6 offset:18432
  buffer_load_dwordx4 v[116:119], v3, s[24:27], s23 offen offset:1024 sc1
  s_waitcnt vmcnt(15)
  v_mfma_f32_32x32x16_bf16 v[16:31], v[200:203], v[120:123], v[16:31]
  s_waitcnt lgkmcnt(2)
  v_mfma_f32_32x32x16_bf16 v[32:47], v[88:91], v[120:123], v[32:47]
  ds_read_b128 v[100:103], v6 offset:19456
  buffer_load_dwordx4 v[120:123], v3, s[24:27], s23 offen offset:2048 sc1
  s_waitcnt vmcnt(15)
  v_mfma_f32_32x32x16_bf16 v[16:31], v[204:207], v[124:127], v[16:31]
  s_waitcnt lgkmcnt(2)
  v_mfma_f32_32x32x16_bf16 v[32:47], v[92:95], v[124:127], v[32:47]
  ds_read_b128 v[88:91], v6 offset:20480
  buffer_load_dwordx4 v[124:127], v3, s[24:27], s23 offen offset:3072 sc1
  s_waitcnt vmcnt(15)
  v_mfma_f32_32x32x16_bf16 v[16:31], v[208:211], v[128:131], v[16:31]
  s_waitcnt lgkmcnt(2)
  v_mfma_f32_32x32x16_bf16 v[32:47], v[96:99], v[128:131], v[32:47]
  ds_read_b128 v[92:95], v6 offset:21504
  s_add_u32 s23, s23, 4096
  buffer_load_dwordx4 v[128:131], v3, s[24:27], s23 offen offset:0 sc1
  s_waitcnt vmcnt(15)
  v_mfma_f32_32x32x16_bf16 v[16:31], v[212:215], v[132:135], v[16:31]
  s_waitcnt lgkmcnt(2)
  v_mfma_f32_32x32x16_bf16 v[32:47], v[100:103], v[132:135], v[32:47]
  ds_read_b128 v[96:99], v6 offset:22528
  buffer_load_dwordx4 v[132:135], v3, s[24:27], s23 offen offset:1024 sc1
  s_waitcnt vmcnt(15)
  v_mfma_f32_32x32x16_bf16 v[16:31], v[216:219], v[136:139], v[16:31]
  s_waitcnt lgkmcnt(2)
  v_mfma_f32_32x32x16_bf16 v[32:47], v[88:91], v[136:139], v[32:47]
  ds_read_b128 v[100:103], v6 offset:23552
  buffer_load_dwordx4 v[136:139], v3, s[24:27], s23 offen offset:2048 sc1
  s_waitcnt vmcnt(15)
  v_mfma_f32_32x32x16_bf16 v[16:31], v[220:223], v[140:143], v[16:31]
  s_waitcnt lgkmcnt(2)
  v_mfma_f32_32x32x16_bf16 v[32:47], v[92:95], v[140:143], v[32:47]
  ds_read_b128 v[88:91], v6 offset:24576
  buffer_load_dwordx4 v[140:143], v3, s[24:27], s23 offen offset:3072 sc1
  s_waitcnt vmcnt(15)
  v_mfma_f32_32x32x16_bf16 v[16:31], v[224:227], v[144:147], v[16:31]
  s_waitcnt lgkmcnt(2)
  v_mfma_f32_32x32x16_bf16 v[32:47], v[96:99], v[144:147], v[32:47]
  ds_read_b128 v[92:95], v6 offset:25600
  s_add_u32 s23, s23, 4096
  buffer_load_dwordx4 v[144:147], v3, s[24:27], s23 offen offset:0 sc1
  s_waitcnt vmcnt(15)
  v_mfma_f32_32x32x16_bf16 v[16:31], v[228:231], v[148:151], v[16:31]
  s_waitcnt lgkmcnt(2)
  v_mfma_f32_32x32x16_bf16 v[32:47], v[100:103], v[148:151], v[32:47]
  buffer_load_dwordx4 v[148:151], v3, s[24:27], s23 offen offset:1024 sc1
  s_waitcnt vmcnt(15)
  v_mfma_f32_32x32x16_bf16 v[16:31], v[232:235], v[152:155], v[16:31]
  s_waitcnt lgkmcnt(1)
  v_mfma_f32_32x32x16_bf16 v[32:47], v[88:91], v[152:155], v[32:47]
  buffer_load_dwordx4 v[152:155], v3, s[24:27], s23 offen offset:2048 sc1
  s_waitcnt vmcnt(15)
  v_mfma_f32_32x32x16_bf16 v[16:31], v[236:239], v[156:159], v[16:31]
  s_waitcnt lgkmcnt(0)
  v_mfma_f32_32x32x16_bf16 v[32:47], v[92:95], v[156:159], v[32:47]
  ds_read_b128 v[88:91], v6 offset:0
  buffer_load_dwordx4 v[156:159], v3, s[24:27], s23 offen offset:3072 sc1
  s_waitcnt vmcnt(15)
  v_mfma_f32_32x32x16_bf16 v[16:31], v[240:243], v[160:163], v[16:31]
  v_mfma_f32_32x32x16_bf16 v[32:47], v[104:107], v[160:163], v[32:47]
  ds_read_b128 v[92:95], v6 offset:1024
  s_add_u32 s23, s23, 4096
  buffer_load_dwordx4 v[160:163], v3, s[24:27], s23 offen offset:0 sc1
  s_waitcnt vmcnt(15)
  v_mfma_f32_32x32x16_bf16 v[16:31], v[244:247], v[164:167], v[16:31]
  v_mfma_f32_32x32x16_bf16 v[32:47], v[108:111], v[164:167], v[32:47]
  ds_read_b128 v[96:99], v6 offset:2048
  buffer_load_dwordx4 v[164:167], v3, s[24:27], s23 offen offset:1024 sc1
  s_waitcnt vmcnt(13)
  v_mfma_f32_32x32x16_bf16 v[48:63], a[224:227], v[112:115], 0
  s_waitcnt lgkmcnt(2)
  v_mfma_f32_32x32x16_bf16 v[64:79], v[88:91], v[112:115], 0
  ds_read_b128 v[100:103], v6 offset:3072
  buffer_load_dwordx4 v[112:115], v3, s[24:27], s23 offen offset:2048 sc1
  s_waitcnt vmcnt(13)
  v_mfma_f32_32x32x16_bf16 v[48:63], a[228:231], v[116:119], v[48:63]
  s_nop 0
  ds_write_b128 v8, v[16:19] offset:0
  s_waitcnt lgkmcnt(3)
  v_mfma_f32_32x32x16_bf16 v[64:79], v[92:95], v[116:119], v[64:79]
  ds_read_b128 v[88:91], v6 offset:4096
  ds_write_b128 v8, v[20:23] offset:1024
  buffer_load_dwordx4 v[116:119], v3, s[24:27], s23 offen offset:3072 sc1
  s_waitcnt vmcnt(13)
  v_mfma_f32_32x32x16_bf16 v[48:63], a[232:235], v[120:123], v[48:63]
  ds_write_b128 v8, v[32:35] offset:8192
  s_waitcnt lgkmcnt(5)
  v_mfma_f32_32x32x16_bf16 v[64:79], v[96:99], v[120:123], v[64:79]
  ds_read_b128 v[92:95], v6 offset:5120
  ds_write_b128 v8, v[36:39] offset:9216
  s_add_u32 s23, s23, 4096
  buffer_load_dwordx4 v[120:123], v3, s[24:27], s23 offen offset:0 sc1
  s_waitcnt vmcnt(13)
  v_mfma_f32_32x32x16_bf16 v[48:63], a[236:239], v[124:127], v[48:63]
  ds_write_b128 v8, v[24:27] offset:16384
  s_waitcnt lgkmcnt(7)
  v_mfma_f32_32x32x16_bf16 v[64:79], v[100:103], v[124:127], v[64:79]
  ds_read_b128 v[96:99], v6 offset:6144
  ds_write_b128 v8, v[28:31] offset:17408
  buffer_load_dwordx4 v[124:127], v3, s[24:27], s23 offen offset:1024 sc1
  s_waitcnt vmcnt(13)
  v_mfma_f32_32x32x16_bf16 v[48:63], a[240:243], v[128:131], v[48:63]
  ds_write_b128 v8, v[40:43] offset:24576
  s_waitcnt lgkmcnt(8)
  v_mfma_f32_32x32x16_bf16 v[64:79], v[88:91], v[128:131], v[64:79]
  ds_read_b128 v[100:103], v6 offset:7168
  ds_write_b128 v8, v[44:47] offset:25600
  buffer_load_dwordx4 v[128:131], v3, s[24:27], s23 offen offset:2048 sc1
  s_waitcnt vmcnt(13)
  v_mfma_f32_32x32x16_bf16 v[48:63], a[244:247], v[132:135], v[48:63]
  s_waitcnt lgkmcnt(7)
  v_mfma_f32_32x32x16_bf16 v[64:79], v[92:95], v[132:135], v[64:79]
  ds_read_b128 v[88:91], v6 offset:8192
  s_waitcnt lgkmcnt(1)
  s_barrier
  buffer_load_dwordx4 v[132:135], v3, s[24:27], s23 offen offset:3072 sc1
  s_waitcnt vmcnt(13)
  v_mfma_f32_32x32x16_bf16 v[48:63], a[248:251], v[136:139], v[48:63]
  ds_read_b128 v[16:19], v9 offset:0
  ds_read_b128 v[20:23], v9 offset:1024
  ds_read_b128 v[24:27], v9 offset:2048
  ds_read_b128 v[28:31], v9 offset:3072
  v_mfma_f32_32x32x16_bf16 v[64:79], v[96:99], v[136:139], v[64:79]
  ds_read_b128 v[92:95], v6 offset:9216
  ds_read_b128 v[32:35], v9 offset:4096
  ds_read_b128 v[36:39], v9 offset:5120
  ds_read_b128 v[40:43], v9 offset:6144
  ds_read_b128 v[44:47], v9 offset:7168
  s_add_u32 s23, s23, 4096
  buffer_load_dwordx4 v[136:139], v3, s[24:27], s23 offen offset:0 sc1
  s_waitcnt vmcnt(13)
  v_mfma_f32_32x32x16_bf16 v[48:63], a[252:255], v[140:143], v[48:63]
  s_waitcnt lgkmcnt(5)
  v_add_f32 v16, v16, v24
  v_add_f32 v17, v17, v25
  v_mfma_f32_32x32x16_bf16 v[64:79], v[100:103], v[140:143], v[64:79]
  ds_read_b128 v[96:99], v6 offset:10240
  v_add_f32 v18, v18, v26
  v_add_f32 v19, v19, v27
  v_add_f32 v20, v20, v28
  v_add_f32 v21, v21, v29
  buffer_load_dwordx4 v[140:143], v3, s[24:27], s23 offen offset:1024 sc1
  s_waitcnt vmcnt(13)
  v_mfma_f32_32x32x16_bf16 v[48:63], v[168:171], v[144:147], v[48:63]
  v_add_f32 v22, v22, v30
  v_add_f32 v23, v23, v31
  s_waitcnt lgkmcnt(1)
  v_add_f32 v32, v32, v40
  v_mfma_f32_32x32x16_bf16 v[64:79], v[88:91], v[144:147], v[64:79]
  ds_read_b128 v[100:103], v6 offset:11264
  v_add_f32 v33, v33, v41
  v_add_f32 v34, v34, v42
  v_add_f32 v35, v35, v43
  buffer_load_dwordx4 v[144:147], v3, s[24:27], s23 offen offset:2048 sc1
  s_waitcnt vmcnt(13)
  v_mfma_f32_32x32x16_bf16 v[48:63], v[172:175], v[148:151], v[48:63]
  v_add_f32 v36, v36, v44
  v_add_f32 v37, v37, v45
  v_add_f32 v38, v38, v46
  v_add_f32 v39, v39, v47
  v_mfma_f32_32x32x16_bf16 v[64:79], v[92:95], v[148:151], v[64:79]
  ds_read_b128 v[88:91], v6 offset:12288
  v_add_f32 v16, v16, v32
  v_add_f32 v17, v17, v33
  v_add_f32 v18, v18, v34
  buffer_load_dwordx4 v[148:151], v3, s[24:27], s23 offen offset:3072 sc1
  s_waitcnt vmcnt(13)
  v_mfma_f32_32x32x16_bf16 v[48:63], v[176:179], v[152:155], v[48:63]
  v_add_f32 v19, v19, v35
  v_add_f32 v20, v20, v36
  v_add_f32 v21, v21, v37
  v_add_f32 v22, v22, v38
  s_waitcnt lgkmcnt(2)
  v_mfma_f32_32x32x16_bf16 v[64:79], v[96:99], v[152:155], v[64:79]
  ds_read_b128 v[92:95], v6 offset:13312
  v_add_f32 v23, v23, v39
  v_permlane32_swap_b32 v16, v20
  v_permlane32_swap_b32 v17, v21
  v_permlane32_swap_b32 v18, v22
  s_add_u32 s23, s23, 4096
  buffer_load_dwordx4 v[152:155], v3, s[24:27], s23 offen offset:0 sc1
  s_waitcnt vmcnt(13)
  v_mfma_f32_32x32x16_bf16 v[48:63], v[180:183], v[156:159], v[48:63]
  v_permlane32_swap_b32 v19, v23
  v_lshlrev_b32 v24, 16, v80
  v_and_b32 v25, 0xffff0000, v80
  s_waitcnt lgkmcnt(2)
  v_mfma_f32_32x32x16_bf16 v[64:79], v[100:103], v[156:159], v[64:79]
  ds_read_b128 v[96:99], v6 offset:14336
  v_add_f32 v16, v16, v24
  v_add_f32 v17, v17, v25
  v_lshlrev_b32 v24, 16, v81
  v_and_b32 v25, 0xffff0000, v81
  buffer_load_dwordx4 v[156:159], v3, s[24:27], s23 offen offset:1024 sc1
  s_waitcnt vmcnt(13)
  v_mfma_f32_32x32x16_bf16 v[48:63], v[184:187], v[160:163], v[48:63]
  v_add_f32 v18, v18, v24
  v_add_f32 v19, v19, v25
  v_lshlrev_b32 v24, 16, v82
  v_and_b32 v25, 0xffff0000, v82
  s_waitcnt lgkmcnt(2)
  v_mfma_f32_32x32x16_bf16 v[64:79], v[88:91], v[160:163], v[64:79]
  ds_read_b128 v[100:103], v6 offset:15360
  v_add_f32 v20, v20, v24
  v_add_f32 v21, v21, v25
  v_lshlrev_b32 v24, 16, v83
  buffer_load_dwordx4 v[160:163], v3, s[24:27], s23 offen offset:2048 sc1
  s_waitcnt vmcnt(13)
  v_mfma_f32_32x32x16_bf16 v[48:63], v[188:191], v[164:167], v[48:63]
  v_and_b32 v25, 0xffff0000, v83
  v_add_f32 v22, v22, v24
  v_add_f32 v23, v23, v25
  v_cvt_pk_bf16_f32 v28, v16, v17
  s_waitcnt lgkmcnt(2)
  v_mfma_f32_32x32x16_bf16 v[64:79], v[92:95], v[164:167], v[64:79]
  ds_read_b128 v[88:91], v6 offset:16384
  v_cvt_pk_bf16_f32 v29, v18, v19
  v_cvt_pk_bf16_f32 v30, v20, v21
  v_cvt_pk_bf16_f32 v31, v22, v23
  buffer_load_dwordx4 v[164:167], v3, s[24:27], s23 offen offset:3072 sc1
  buffer_store_dwordx4 v[28:31], v10, s[36:39], s40 offen
  s_waitcnt vmcnt(14)
  v_mfma_f32_32x32x16_bf16 v[48:63], v[192:195], v[112:115], v[48:63]
  s_waitcnt lgkmcnt(2)
  v_mfma_f32_32x32x16_bf16 v[64:79], v[96:99], v[112:115], v[64:79]
  ds_read_b128 v[92:95], v6 offset:17408
  s_waitcnt vmcnt(13)
  v_mfma_f32_32x32x16_bf16 v[48:63], v[196:199], v[116:119], v[48:63]
  s_waitcnt lgkmcnt(2)
  v_mfma_f32_32x32x16_bf16 v[64:79], v[100:103], v[116:119], v[64:79]
  ds_read_b128 v[96:99], v6 offset:18432
  s_waitcnt vmcnt(12)
  v_mfma_f32_32x32x16_bf16 v[48:63], v[200:203], v[120:123], v[48:63]
  s_waitcnt lgkmcnt(2)
  v_mfma_f32_32x32x16_bf16 v[64:79], v[88:91], v[120:123], v[64:79]
  ds_read_b128 v[100:103], v6 offset:19456
  s_waitcnt vmcnt(11)
  v_mfma_f32_32x32x16_bf16 v[48:63], v[204:207], v[124:127], v[48:63]
  s_waitcnt lgkmcnt(2)
  v_mfma_f32_32x32x16_bf16 v[64:79], v[92:95], v[124:127], v[64:79]
  ds_read_b128 v[88:91], v6 offset:20480
  s_waitcnt vmcnt(10)
  v_mfma_f32_32x32x16_bf16 v[48:63], v[208:211], v[128:131], v[48:63]
  s_waitcnt lgkmcnt(2)
  v_mfma_f32_32x32x16_bf16 v[64:79], v[96:99], v[128:131], v[64:79]
  ds_read_b128 v[92:95], v6 offset:21504
  s_waitcnt vmcnt(9)
  v_mfma_f32_32x32x16_bf16 v[48:63], v[212:215], v[132:135], v[48:63]
  s_waitcnt lgkmcnt(2)
  v_mfma_f32_32x32x16_bf16 v[64:79], v[100:103], v[132:135], v[64:79]
  ds_read_b128 v[96:99], v6 offset:22528
  s_waitcnt vmcnt(8)
  v_mfma_f32_32x32x16_bf16 v[48:63], v[216:219], v[136:139], v[48:63]
  s_waitcnt lgkmcnt(2)
  v_mfma_f32_32x32x16_bf16 v[64:79], v[88:91], v[136:139], v[64:79]
  ds_read_b128 v[100:103], v6 offset:23552
  s_barrier
  s_waitcnt vmcnt(7)
  v_mfma_f32_32x32x16_bf16 v[48:63], v[220:223], v[140:143], v[48:63]
  s_waitcnt lgkmcnt(2)
  v_mfma_f32_32x32x16_bf16 v[64:79], v[92:95], v[140:143], v[64:79]
  ds_read_b128 v[88:91], v6 offset:24576
  s_waitcnt vmcnt(6)
  v_mfma_f32_32x32x16_bf16 v[48:63], v[224:227], v[144:147], v[48:63]
  s_waitcnt lgkmcnt(2)
  v_mfma_f32_32x32x16_bf16 v[64:79], v[96:99], v[144:147], v[64:79]
  ds_read_b128 v[92:95], v6 offset:25600
  s_waitcnt vmcnt(5)
  v_mfma_f32_32x32x16_bf16 v[48:63], v[228:231], v[148:151], v[48:63]
  s_waitcnt lgkmcnt(2)
  v_mfma_f32_32x32x16_bf16 v[64:79], v[100:103], v[148:151], v[64:79]
  s_waitcnt vmcnt(4)
  v_mfma_f32_32x32x16_bf16 v[48:63], v[232:235], v[152:155], v[48:63]
  s_waitcnt lgkmcnt(1)
  v_mfma_f32_32x32x16_bf16 v[64:79], v[88:91], v[152:155], v[64:79]
  s_waitcnt vmcnt(3)
  v_mfma_f32_32x32x16_bf16 v[48:63], v[236:239], v[156:159], v[48:63]
  s_waitcnt lgkmcnt(0)
  v_mfma_f32_32x32x16_bf16 v[64:79], v[92:95], v[156:159], v[64:79]
  s_waitcnt vmcnt(2)
  v_mfma_f32_32x32x16_bf16 v[48:63], v[240:243], v[160:163], v[48:63]
  v_mfma_f32_32x32x16_bf16 v[64:79], v[104:107], v[160:163], v[64:79]
  s_waitcnt vmcnt(1)
  v_mfma_f32_32x32x16_bf16 v[48:63], v[244:247], v[164:167], v[48:63]
  v_mfma_f32_32x32x16_bf16 v[64:79], v[108:111], v[164:167], v[64:79]
  s_nop 10
  ds_write_b128 v8, v[48:51] offset:0
  ds_write_b128 v8, v[52:55] offset:1024
  ds_write_b128 v8, v[64:67] offset:8192
  ds_write_b128 v8, v[68:71] offset:9216
  ds_write_b128 v8, v[56:59] offset:16384
  ds_write_b128 v8, v[60:63] offset:17408
  ds_write_b128 v8, v[72:75] offset:24576
  ds_write_b128 v8, v[76:79] offset:25600
  s_waitcnt lgkmcnt(0)
  s_barrier
  ds_read_b128 v[48:51], v9 offset:0
  ds_read_b128 v[52:55], v9 offset:1024
  ds_read_b128 v[56:59], v9 offset:2048
  ds_read_b128 v[60:63], v9 offset:3072
  ds_read_b128 v[64:67], v9 offset:4096
  ds_read_b128 v[68:71], v9 offset:5120
  ds_read_b128 v[72:75], v9 offset:6144
  ds_read_b128 v[76:79], v9 offset:7168
  s_waitcnt lgkmcnt(4)
  v_add_f32 v48, v48, v56
  v_add_f32 v49, v49, v57
  v_add_f32 v50, v50, v58
  v_add_f32 v51, v51, v59
  v_add_f32 v52, v52, v60
  v_add_f32 v53, v53, v61
  v_add_f32 v54, v54, v62
  v_add_f32 v55, v55, v63
  s_waitcnt lgkmcnt(0)
  v_add_f32 v64, v64, v72
  v_add_f32 v65, v65, v73
  v_add_f32 v66, v66, v74
  v_add_f32 v67, v67, v75
  v_add_f32 v68, v68, v76
  v_add_f32 v69, v69, v77
  v_add_f32 v70, v70, v78
  v_add_f32 v71, v71, v79
  v_add_f32 v48, v48, v64
  v_add_f32 v49, v49, v65
  v_add_f32 v50, v50, v66
  v_add_f32 v51, v51, v67
  v_add_f32 v52, v52, v68
  v_add_f32 v53, v53, v69
  v_add_f32 v54, v54, v70
  v_add_f32 v55, v55, v71
  v_permlane32_swap_b32 v48, v52
  v_permlane32_swap_b32 v49, v53
  v_permlane32_swap_b32 v50, v54
  v_permlane32_swap_b32 v51, v55
  v_lshlrev_b32 v56, 16, v84
  v_and_b32 v57, 0xffff0000, v84
  v_add_f32 v48, v48, v56
  v_add_f32 v49, v49, v57
  v_lshlrev_b32 v56, 16, v85
  v_and_b32 v57, 0xffff0000, v85
  v_add_f32 v50, v50, v56
  v_add_f32 v51, v51, v57
  v_lshlrev_b32 v56, 16, v86
  v_and_b32 v57, 0xffff0000, v86
  v_add_f32 v52, v52, v56
  v_add_f32 v53, v53, v57
  v_lshlrev_b32 v56, 16, v87
  v_and_b32 v57, 0xffff0000, v87
  v_add_f32 v54, v54, v56
  v_add_f32 v55, v55, v57
  v_cvt_pk_bf16_f32 v60, v48, v49
  v_cvt_pk_bf16_f32 v61, v50, v51
  v_cvt_pk_bf16_f32 v62, v52, v53
  v_cvt_pk_bf16_f32 v63, v54, v55
  buffer_store_dwordx4 v[60:63], v10, s[36:39], s41 offen
L_gskip_106:
L_end:
  s_endpgm
.section .rodata,"a"
.p2align 6
.amdhsa_kernel interleave_layers__ssm_conv_h3__swiglu_ffn__prompt_kernel
  .amdhsa_next_free_vgpr 512
  .amdhsa_next_free_sgpr 102
  .amdhsa_accum_offset 256
  .amdhsa_group_segment_fixed_size 0
  .amdhsa_kernarg_size 104
  .amdhsa_user_sgpr_count 2
  .amdhsa_user_sgpr_kernarg_segment_ptr 1
  .amdhsa_system_sgpr_workgroup_id_x 1
  .amdhsa_float_denorm_mode_32 3
  .amdhsa_float_denorm_mode_16_64 3
.end_amdhsa_kernel
```
